```python
import torch

def _softmax(x, axis=-1):
    return torch.softmax(x, dim=axis)
def _gelu(x):
    return torch.nn.functional.gelu(x, approximate="tanh")
def _silu(x):
    return torch.nn.functional.silu(x)
def _sigmoid(x):
    return torch.sigmoid(x)
def _layernorm(x, axis=-1, eps=1e-5):
    m = x.mean(dim=axis, keepdim=True)
    v = x.var(dim=axis, keepdim=True, unbiased=False)
    return (x - m) / torch.sqrt(v + eps)
def _scatter_add(tgt, idx, src, axis=0):
    return tgt.clone().index_add_(axis, idx, src)
def _segment_sum(src, seg, n):
    out = torch.zeros((n,) + src.shape[1:], dtype=src.dtype)
    return out.index_add_(0, seg, src)
def _pad(x, pw):
    flat = tuple(v for pair in reversed(pw) for v in pair)
    return torch.nn.functional.pad(x, flat)

kernel_name = 'standalone__gqa_softmax__near_ridge'

def setup_inputs():

    _w = (lambda a: (lambda t: t.to(torch.bfloat16) if t.is_floating_point() else t)(torch.as_tensor(a)))
    B, Hq, Hkv, Sq, Sk, D = 8, 32, 8, 256, 512, 128
    return {
        "q": _w((lambda *s: torch.randn(*s, dtype=torch.bfloat16) * 0.8)(B, Hq, Sq, D)),
        "k": _w((lambda *s: torch.randn(*s, dtype=torch.bfloat16) * 0.8)(B, Hkv, Sk, D)),
        "v": _w((lambda *s: torch.randn(*s, dtype=torch.bfloat16) * 0.05)(B, Hkv, Sk, D)),
    }

def reference(q, k, v):
    B, Hq, Sq, D = q.shape
    Hkv = k.shape[1]
    rep = Hq // Hkv
    k = (lambda x, n, axis: torch.repeat_interleave(x, n, dim=axis))(k, rep, axis=1)
    v = (lambda x, n, axis: torch.repeat_interleave(x, n, dim=axis))(v, rep, axis=1)
    scale = D ** -0.5
    scores = torch.einsum("bhqd,bhkd->bhqk", q, k) * scale
    p = _softmax(scores, axis=-1)
    return torch.einsum("bhqk,bhkd->bhqd", p, v)
```

```asm
; @launch grid=(256,1,1) block=(512,1,1) lds=163840
.amdgcn_target "amdgcn-amd-amdhsa--gfx950"
.text
.globl standalone__gqa_softmax__near_ridge_kernel
.p2align 8
.type standalone__gqa_softmax__near_ridge_kernel,@function
standalone__gqa_softmax__near_ridge_kernel:
    s_load_dwordx4 s[4:7], s[0:1], 0
    s_load_dwordx4 s[32:35], s[0:1], 16
    s_cmp_ge_u32 s2, 256
    s_cbranch_scc1 L_end
    v_lshrrev_b32 v1, 6, v0
    v_and_b32 v0, 63, v0
    v_readfirstlane_b32 s30, v1
    s_and_b32 s36, s2, 7
    s_lshr_b32 s37, s2, 3
    s_lshl_b32 s38, s36, 5
    s_add_u32 s38, s38, s37
    s_lshl_b32 s26, s38, 16
    s_lshl_b32 s38, s36, 3
    s_lshr_b32 s37, s37, 2
    s_add_u32 s38, s38, s37
    s_lshl_b32 s25, s38, 17
    s_mov_b32 s28, 0
    s_mov_b32 s27, 0x3e0293ee
    s_lshl_b32 s36, s30, 13
    s_add_u32 s26, s26, s36
    s_and_b32 s36, s30, 3
    s_lshl_b32 s24, s36, 12
    s_lshr_b32 s40, s30, 2
    s_lshl_b32 s39, s36, 13
    s_add_u32 s39, s39, 131072
L_restart:
    v_lshrrev_b32 v1, 4, v0
    v_and_b32 v2, 15, v0
    v_xor_b32 v3, v1, v2
    v_lshlrev_b32 v248, 8, v1
    v_lshl_add_u32 v244, v3, 4, v248
    v_xor_b32 v245, 64, v244
    v_xor_b32 v246, 128, v244
    v_xor_b32 v247, 192, v244
    v_lshlrev_b32 v3, 1, v1
    v_xor_b32 v3, v3, v2
    v_lshl_add_u32 v248, v3, 4, v248
    v_xor_b32 v249, 128, v248
    s_add_u32 s38, s25, s24
    s_mov_b32 s41, 0
    s_waitcnt lgkmcnt(0)
    s_mov_b32 s8, s6
    s_and_b32 s9, s7, 0xffff
    s_mov_b32 s10, 8388608
    s_mov_b32 s11, 0x20000
    s_cmp_lg_u32 s40, 0
    s_cbranch_scc1 L_proB
    s_add_u32 m0, s24, 0
    s_add_u32 s29, s38, 0
    buffer_load_dwordx4 v244, s[8:11], s29 offen offset:0  lds
    buffer_load_dwordx4 v245, s[8:11], s29 offen offset:1024  lds
    buffer_load_dwordx4 v246, s[8:11], s29 offen offset:2048  lds
    buffer_load_dwordx4 v247, s[8:11], s29 offen offset:3072  lds
    s_mov_b32 s16, s4
    s_and_b32 s17, s5, 0xffff
    s_mov_b32 s18, 16777216
    s_mov_b32 s19, 0x20000
    s_add_u32 m0, s39, 0
    s_add_u32 s29, s26, 0
    buffer_load_dwordx4 v244, s[16:19], s29 offen offset:0  lds
    buffer_load_dwordx4 v245, s[16:19], s29 offen offset:1024  lds
    buffer_load_dwordx4 v246, s[16:19], s29 offen offset:2048  lds
    buffer_load_dwordx4 v247, s[16:19], s29 offen offset:3072  lds
    s_add_u32 m0, s39, 4096
    s_add_u32 s29, s26, 4096
    buffer_load_dwordx4 v244, s[16:19], s29 offen offset:0  lds
    buffer_load_dwordx4 v245, s[16:19], s29 offen offset:1024  lds
    buffer_load_dwordx4 v246, s[16:19], s29 offen offset:2048  lds
    buffer_load_dwordx4 v247, s[16:19], s29 offen offset:3072  lds
    s_mov_b32 s36, s27
    s_mov_b32 s12, s32
    s_and_b32 s13, s33, 0xffff
    s_mov_b32 s14, 8388608
    s_mov_b32 s15, 0x20000
    s_mov_b32 s20, s34
    s_and_b32 s21, s35, 0xffff
    s_mov_b32 s22, 16777216
    s_mov_b32 s23, 0x20000
    v_and_b32 v1, 15, v0
    v_lshrrev_b32 v3, 4, v0
    v_xor_b32 v2, v1, v3
    v_lshlrev_b32 v2, 4, v2
    v_lshl_add_u32 v232, v1, 8, v2
    v_xor_b32 v233, 64, v232
    v_xor_b32 v234, 128, v232
    v_xor_b32 v235, 192, v232
    v_lshrrev_b32 v1, 2, v0
    v_and_b32 v2, 7, v1
    v_lshlrev_b32 v2, 5, v2
    v_lshl_add_u32 v2, v1, 8, v2
    v_and_b32 v1, 3, v0
    v_lshl_add_u32 v2, v1, 3, v2
    v_add_u32 v236, 65536, v2
    v_xor_b32 v237, 32, v236
    v_xor_b32 v238, 64, v236
    v_xor_b32 v239, 96, v236
    v_xor_b32 v240, 128, v236
    v_xor_b32 v241, 160, v236
    v_xor_b32 v242, 192, v236
    v_xor_b32 v243, 224, v236
    v_add_u32 v180, s39, v232
    v_add_u32 v181, s39, v233
    v_add_u32 v182, s39, v234
    v_add_u32 v183, s39, v235
    v_mov_b32 v220, 0x3f803f80
    v_mov_b32 v221, 0x3f803f80
    v_mov_b32 v222, 0x3f803f80
    v_mov_b32 v223, 0x3f803f80
    v_mov_b32 v212, 0
    v_mov_b32 v213, 0
    v_mov_b32 v214, 0
    v_mov_b32 v215, 0
    v_mov_b32 v216, 0
    v_mov_b32 v217, 0
    v_mov_b32 v218, 0
    v_mov_b32 v219, 0
    v_and_b32 v1, 1, v0
    v_mul_u32_u24 v1, 0xaaaa, v1
    v_add_u32 v1, 0x4444, v1
    v_lshl_add_u32 v253, v1, 16, v1
    s_lshl_b32 s37, s30, 12
    s_add_u32 s37, s37, 131072
    v_and_b32 v1, 15, v0
    v_lshlrev_b32 v2, 7, v1
    v_and_b32 v250, 1, v3
    v_lshl_add_u32 v2, v250, 3, v2
    v_and_b32 v1, 7, v1
    v_lshrrev_b32 v250, 1, v3
    v_xor_b32 v1, v1, v250
    v_lshl_add_u32 v2, v1, 4, v2
    v_add_u32 v250, s37, v2
    v_lshlrev_b32 v251, 4, v0
    v_add_u32 v251, s37, v251
    v_lshrrev_b32 v1, 3, v0
    v_and_b32 v2, 7, v0
    v_xor_b32 v2, v2, v1
    v_lshlrev_b32 v1, 8, v1
    v_lshl_add_u32 v252, v2, 4, v1
    v_bfe_u32 v1, v0, 2, 2
    v_lshrrev_b32 v2, 4, v0
    v_cmp_eq_u32 vcc, v1, v2
    v_and_b32 v1, 1, v0
    v_lshlrev_b32 v1, 4, v1
    v_and_b32 v2, 2, v0
    v_cmp_eq_u32 s[42:43], 0, v2
    v_mov_b32 v3, 15875
    v_lshlrev_b32 v3, v1, v3
    v_cndmask_b32 v3, 0, v3, vcc
    v_cndmask_b32 v70, 0, v3, s[42:43]
    v_cndmask_b32 v71, v3, 0, s[42:43]
    v_mov_b32 v68, 0
    v_mov_b32 v69, 0
    v_mov_b32 v72, 0
    v_mov_b32 v73, 0
    v_mov_b32 v3, 47576
    v_lshlrev_b32 v3, v1, v3
    v_cndmask_b32 v3, 0, v3, vcc
    v_cndmask_b32 v76, 0, v3, s[42:43]
    v_cndmask_b32 v77, v3, 0, s[42:43]
    v_mov_b32 v74, 0
    v_mov_b32 v75, 0
    v_mov_b32 v78, 0
    v_mov_b32 v79, 0
    s_waitcnt vmcnt(8)
    s_branch L_main
L_proB:
    s_mov_b32 s16, s4
    s_and_b32 s17, s5, 0xffff
    s_mov_b32 s18, 16777216
    s_mov_b32 s19, 0x20000
    s_mov_b32 s12, s32
    s_and_b32 s13, s33, 0xffff
    s_mov_b32 s14, 8388608
    s_mov_b32 s15, 0x20000
    s_mov_b32 s20, s34
    s_and_b32 s21, s35, 0xffff
    s_mov_b32 s22, 16777216
    s_mov_b32 s23, 0x20000
    v_and_b32 v1, 15, v0
    v_lshrrev_b32 v3, 4, v0
    v_xor_b32 v2, v1, v3
    v_lshlrev_b32 v2, 4, v2
    v_lshl_add_u32 v232, v1, 8, v2
    v_xor_b32 v233, 64, v232
    v_xor_b32 v234, 128, v232
    v_xor_b32 v235, 192, v232
    v_lshrrev_b32 v1, 2, v0
    v_and_b32 v2, 7, v1
    v_lshlrev_b32 v2, 5, v2
    v_lshl_add_u32 v2, v1, 8, v2
    v_and_b32 v1, 3, v0
    v_lshl_add_u32 v2, v1, 3, v2
    v_add_u32 v236, 65536, v2
    v_xor_b32 v237, 32, v236
    v_xor_b32 v238, 64, v236
    v_xor_b32 v239, 96, v236
    v_xor_b32 v240, 128, v236
    v_xor_b32 v241, 160, v236
    v_xor_b32 v242, 192, v236
    v_xor_b32 v243, 224, v236
    v_add_u32 v180, s39, v232
    v_add_u32 v181, s39, v233
    v_add_u32 v182, s39, v234
    v_add_u32 v183, s39, v235
    v_mov_b32 v220, 0x3f803f80
    v_mov_b32 v221, 0x3f803f80
    v_mov_b32 v222, 0x3f803f80
    v_mov_b32 v223, 0x3f803f80
    v_mov_b32 v212, 0
    v_mov_b32 v213, 0
    v_mov_b32 v214, 0
    v_mov_b32 v215, 0
    v_mov_b32 v216, 0
    v_mov_b32 v217, 0
    v_mov_b32 v218, 0
    v_mov_b32 v219, 0
    v_and_b32 v1, 1, v0
    v_mul_u32_u24 v1, 0xaaaa, v1
    v_add_u32 v1, 0x4444, v1
    v_lshl_add_u32 v253, v1, 16, v1
    s_lshl_b32 s37, s30, 12
    s_add_u32 s37, s37, 131072
    v_and_b32 v1, 15, v0
    v_lshlrev_b32 v2, 7, v1
    v_and_b32 v250, 1, v3
    v_lshl_add_u32 v2, v250, 3, v2
    v_and_b32 v1, 7, v1
    v_lshrrev_b32 v250, 1, v3
    v_xor_b32 v1, v1, v250
    v_lshl_add_u32 v2, v1, 4, v2
    v_add_u32 v250, s37, v2
    v_lshlrev_b32 v251, 4, v0
    v_add_u32 v251, s37, v251
    v_lshrrev_b32 v1, 3, v0
    v_and_b32 v2, 7, v0
    v_xor_b32 v2, v2, v1
    v_lshlrev_b32 v1, 8, v1
    v_lshl_add_u32 v252, v2, 4, v1
    v_bfe_u32 v1, v0, 2, 2
    v_lshrrev_b32 v2, 4, v0
    v_cmp_eq_u32 vcc, v1, v2
    v_and_b32 v1, 1, v0
    v_lshlrev_b32 v1, 4, v1
    v_and_b32 v2, 2, v0
    v_cmp_eq_u32 s[42:43], 0, v2
    v_mov_b32 v3, 15875
    v_lshlrev_b32 v3, v1, v3
    v_cndmask_b32 v3, 0, v3, vcc
    v_cndmask_b32 v70, 0, v3, s[42:43]
    v_cndmask_b32 v71, v3, 0, s[42:43]
    v_mov_b32 v68, 0
    v_mov_b32 v69, 0
    v_mov_b32 v72, 0
    v_mov_b32 v73, 0
    v_mov_b32 v3, 47576
    v_lshlrev_b32 v3, v1, v3
    v_cndmask_b32 v3, 0, v3, vcc
    v_cndmask_b32 v76, 0, v3, s[42:43]
    v_cndmask_b32 v77, v3, 0, s[42:43]
    v_mov_b32 v74, 0
    v_mov_b32 v75, 0
    v_mov_b32 v78, 0
    v_mov_b32 v79, 0
    s_add_u32 m0, s24, 16384
    s_add_u32 s29, s38, 16384
    buffer_load_dwordx4 v244, s[8:11], s29 offen offset:0  lds
    buffer_load_dwordx4 v245, s[8:11], s29 offen offset:1024  lds
    buffer_load_dwordx4 v246, s[8:11], s29 offen offset:2048  lds
    buffer_load_dwordx4 v247, s[8:11], s29 offen offset:3072  lds
    s_add_u32 m0, s24, 65536
    s_add_u32 s29, s38, 0
    buffer_load_dwordx4 v248, s[12:15], s29 offen offset:0  lds
    buffer_load_dwordx4 v249, s[12:15], s29 offen offset:1024  lds
    buffer_load_dwordx4 v248, s[12:15], s29 offen offset:2048  lds
    buffer_load_dwordx4 v249, s[12:15], s29 offen offset:3072  lds
    s_barrier
    s_add_u32 m0, s24, 32768
    s_add_u32 s29, s38, 32768
    buffer_load_dwordx4 v244, s[8:11], s29 offen offset:0  lds
    buffer_load_dwordx4 v245, s[8:11], s29 offen offset:1024  lds
    buffer_load_dwordx4 v246, s[8:11], s29 offen offset:2048  lds
    buffer_load_dwordx4 v247, s[8:11], s29 offen offset:3072  lds
    s_add_u32 m0, s24, 81920
    s_add_u32 s29, s38, 16384
    buffer_load_dwordx4 v248, s[12:15], s29 offen offset:0  lds
    buffer_load_dwordx4 v249, s[12:15], s29 offen offset:1024  lds
    buffer_load_dwordx4 v248, s[12:15], s29 offen offset:2048  lds
    buffer_load_dwordx4 v249, s[12:15], s29 offen offset:3072  lds
    v_lshlrev_b32 v1, 7, v0
    buffer_load_dword v2, v1, s[16:19], s26 offen
    s_waitcnt vmcnt(9)
    s_barrier
    s_add_u32 m0, s39, 0
    s_add_u32 s29, s26, 0
    buffer_load_dwordx4 v244, s[16:19], s29 offen offset:0  lds
    buffer_load_dwordx4 v245, s[16:19], s29 offen offset:1024  lds
    buffer_load_dwordx4 v246, s[16:19], s29 offen offset:2048  lds
    buffer_load_dwordx4 v247, s[16:19], s29 offen offset:3072  lds
    s_add_u32 m0, s39, 4096
    s_add_u32 s29, s26, 4096
    buffer_load_dwordx4 v244, s[16:19], s29 offen offset:0  lds
    buffer_load_dwordx4 v245, s[16:19], s29 offen offset:1024  lds
    buffer_load_dwordx4 v246, s[16:19], s29 offen offset:2048  lds
    buffer_load_dwordx4 v247, s[16:19], s29 offen offset:3072  lds
    s_add_u32 m0, s24, 49152
    s_add_u32 s29, s38, 49152
    buffer_load_dwordx4 v244, s[8:11], s29 offen offset:0  lds
    buffer_load_dwordx4 v245, s[8:11], s29 offen offset:1024  lds
    buffer_load_dwordx4 v246, s[8:11], s29 offen offset:2048  lds
    buffer_load_dwordx4 v247, s[8:11], s29 offen offset:3072  lds
    s_mov_b32 s36, s27
    s_waitcnt vmcnt(13)
L_main:
    s_cmp_lg_u32 s40, 0
    s_cselect_b64 vcc, -1, 0
    s_barrier
    ds_read_b128 v[148:151], v232 offset:0
    ds_read_b128 v[152:155], v233 offset:0
    ds_read_b128 v[156:159], v234 offset:0
    ds_read_b128 v[160:163], v235 offset:0
    ds_read_b128 v[164:167], v232 offset:4096
    ds_read_b128 v[168:171], v233 offset:4096
    ds_read_b128 v[172:175], v234 offset:4096
    ds_read_b128 v[176:179], v235 offset:4096
    s_cmp_lg_u32 s40, 0
    s_cbranch_scc1 L_bq
    s_waitcnt vmcnt(0)
    s_branch L_haveq
L_bq:
    s_add_u32 m0, s24, 98304
    s_add_u32 s29, s38, 32768
    buffer_load_dwordx4 v248, s[12:15], s29 offen offset:0  lds
    buffer_load_dwordx4 v249, s[12:15], s29 offen offset:1024  lds
    buffer_load_dwordx4 v248, s[12:15], s29 offen offset:2048  lds
    buffer_load_dwordx4 v249, s[12:15], s29 offen offset:3072  lds
    s_waitcnt vmcnt(8)
L_haveq:
    ds_read_b128 v[4:7], v180 offset:0
    ds_read_b128 v[8:11], v181 offset:0
    ds_read_b128 v[12:15], v182 offset:0
    ds_read_b128 v[16:19], v183 offset:0
    ds_read_b128 v[20:23], v180 offset:4096
    ds_read_b128 v[24:27], v181 offset:4096
    ds_read_b128 v[28:31], v182 offset:4096
    ds_read_b128 v[32:35], v183 offset:4096
    s_waitcnt lgkmcnt(0)
    v_mfma_f32_16x16x32_bf16 v[100:103], v[148:151], v[4:7], 0
    v_mfma_f32_16x16x32_bf16 v[100:103], v[152:155], v[8:11], v[100:103]
    v_mfma_f32_16x16x32_bf16 v[100:103], v[156:159], v[12:15], v[100:103]
    v_mfma_f32_16x16x32_bf16 v[100:103], v[160:163], v[16:19], v[100:103]
    v_mfma_f32_16x16x32_bf16 v[108:111], v[148:151], v[20:23], 0
    ds_read_b128 v[148:151], v232 offset:8192
    v_mfma_f32_16x16x32_bf16 v[108:111], v[152:155], v[24:27], v[108:111]
    ds_read_b128 v[152:155], v233 offset:8192
    v_mfma_f32_16x16x32_bf16 v[108:111], v[156:159], v[28:31], v[108:111]
    ds_read_b128 v[156:159], v234 offset:8192
    v_mfma_f32_16x16x32_bf16 v[108:111], v[160:163], v[32:35], v[108:111]
    ds_read_b128 v[160:163], v235 offset:8192
    v_mfma_f32_16x16x32_bf16 v[104:107], v[164:167], v[4:7], 0
    v_mfma_f32_16x16x32_bf16 v[104:107], v[168:171], v[8:11], v[104:107]
    v_mfma_f32_16x16x32_bf16 v[104:107], v[172:175], v[12:15], v[104:107]
    v_mfma_f32_16x16x32_bf16 v[104:107], v[176:179], v[16:19], v[104:107]
    v_mfma_f32_16x16x32_bf16 v[112:115], v[164:167], v[20:23], 0
    ds_read_b128 v[164:167], v232 offset:12288
    v_mfma_f32_16x16x32_bf16 v[112:115], v[168:171], v[24:27], v[112:115]
    ds_read_b128 v[168:171], v233 offset:12288
    v_mfma_f32_16x16x32_bf16 v[112:115], v[172:175], v[28:31], v[112:115]
    ds_read_b128 v[172:175], v234 offset:12288
    v_mfma_f32_16x16x32_bf16 v[112:115], v[176:179], v[32:35], v[112:115]
    ds_read_b128 v[176:179], v235 offset:12288
    s_waitcnt lgkmcnt(4)
    v_mfma_f32_16x16x32_bf16 v[116:119], v[148:151], v[4:7], 0
    v_mfma_f32_16x16x32_bf16 v[116:119], v[152:155], v[8:11], v[116:119]
    v_mfma_f32_16x16x32_bf16 v[116:119], v[156:159], v[12:15], v[116:119]
    v_mfma_f32_16x16x32_bf16 v[116:119], v[160:163], v[16:19], v[116:119]
    s_nop 3
    s_cmp_lg_u32 s28, 0
    s_cbranch_scc1 L_have_m
    v_max3_f32 v224, v100, v101, v102
    v_max3_f32 v228, v108, v109, v110
    v_max3_f32 v188, v103, v104, v105
    v_max3_f32 v189, v111, v112, v113
    v_max3_f32 v224, v224, v106, v107
    v_max3_f32 v228, v228, v114, v115
    v_max_f32 v224, v224, v188
    v_max_f32 v228, v228, v189
    v_mov_b32 v188, v224
    v_mov_b32 v189, v228
    s_nop 1
    v_permlane32_swap_b32 v224, v188
    v_permlane32_swap_b32 v228, v189
    v_max_f32 v224, v224, v188
    v_max_f32 v228, v228, v189
    v_mov_b32 v188, v224
    v_mov_b32 v189, v228
    s_nop 1
    v_permlane16_swap_b32 v224, v188
    v_permlane16_swap_b32 v228, v189
    v_max_f32 v224, v224, v188
    v_max_f32 v228, v228, v189
    v_mul_f32 v224, s36, v224
    v_mul_f32 v228, s36, v228
    v_sub_f32 v224, 0, v224
    v_sub_f32 v228, 0, v228
L_have_m:
    v_fma_f32 v100, v100, s36, v224
    v_mfma_f32_16x16x32_bf16 v[124:127], v[148:151], v[20:23], 0
    v_fma_f32 v101, v101, s36, v224
    v_exp_f32 v100, v100
    v_mfma_f32_16x16x32_bf16 v[124:127], v[152:155], v[24:27], v[124:127]
    v_fma_f32 v102, v102, s36, v224
    v_exp_f32 v101, v101
    s_waitcnt lgkmcnt(0)
    v_mfma_f32_16x16x32_bf16 v[124:127], v[156:159], v[28:31], v[124:127]
    v_fma_f32 v103, v103, s36, v224
    v_exp_f32 v102, v102
    v_cvt_pk_bf16_f32 v132, v100, v101
    v_mfma_f32_16x16x32_bf16 v[124:127], v[160:163], v[32:35], v[124:127]
    v_fma_f32 v104, v104, s36, v224
    v_exp_f32 v103, v103
    v_mfma_f32_16x16x32_bf16 v[120:123], v[164:167], v[4:7], 0
    v_fma_f32 v105, v105, s36, v224
    v_exp_f32 v104, v104
    v_cvt_pk_bf16_f32 v133, v102, v103
    v_mfma_f32_16x16x32_bf16 v[120:123], v[168:171], v[8:11], v[120:123]
    v_fma_f32 v106, v106, s36, v224
    v_exp_f32 v105, v105
    v_mfma_f32_16x16x32_bf16 v[120:123], v[172:175], v[12:15], v[120:123]
    v_fma_f32 v107, v107, s36, v224
    v_exp_f32 v106, v106
    v_cvt_pk_bf16_f32 v134, v104, v105
    v_mfma_f32_16x16x32_bf16 v[120:123], v[176:179], v[16:19], v[120:123]
    v_fma_f32 v108, v108, s36, v228
    v_exp_f32 v107, v107
    v_mfma_f32_16x16x32_bf16 v[128:131], v[164:167], v[20:23], 0
    v_fma_f32 v109, v109, s36, v228
    v_exp_f32 v108, v108
    v_cvt_pk_bf16_f32 v135, v106, v107
    v_mfma_f32_16x16x32_bf16 v[128:131], v[168:171], v[24:27], v[128:131]
    v_mfma_f32_16x16x32_bf16 v[128:131], v[172:175], v[28:31], v[128:131]
    v_fma_f32 v110, v110, s36, v228
    v_exp_f32 v109, v109
    v_mfma_f32_16x16x32_bf16 v[128:131], v[176:179], v[32:35], v[128:131]
    s_waitcnt vmcnt(0)
    s_barrier
    v_mfma_f32_16x16x32_bf16 v[36:39], v[70:73], v[4:7], 0
    ds_read_b128 v[148:151], v232 offset:16384
    ds_read_b128 v[152:155], v233 offset:16384
    v_fma_f32 v111, v111, s36, v228
    v_mfma_f32_16x16x32_bf16 v[36:39], v[76:79], v[4:7], v[36:39]
    ds_read_b128 v[156:159], v234 offset:16384
    v_exp_f32 v110, v110
    v_cvt_pk_bf16_f32 v140, v108, v109
    v_mfma_f32_16x16x32_bf16 v[40:43], v[68:71], v[4:7], 0
    ds_read_b128 v[160:163], v235 offset:16384
    v_fma_f32 v112, v112, s36, v228
    v_exp_f32 v111, v111
    v_mfma_f32_16x16x32_bf16 v[40:43], v[74:77], v[4:7], v[40:43]
    ds_read_b128 v[164:167], v232 offset:20480
    v_fma_f32 v113, v113, s36, v228
    v_exp_f32 v112, v112
    v_mfma_f32_16x16x32_bf16 v[44:47], v[70:73], v[8:11], 0
    ds_read_b128 v[168:171], v233 offset:20480
    ds_read_b128 v[172:175], v234 offset:20480
    v_mfma_f32_16x16x32_bf16 v[44:47], v[76:79], v[8:11], v[44:47]
    ds_read_b128 v[176:179], v235 offset:20480
    v_cvt_pk_bf16_f32 v141, v110, v111
    v_mfma_f32_16x16x32_bf16 v[48:51], v[68:71], v[8:11], 0
    v_cvt_pk_bf16_f32 v4, v36, v37
    v_cvt_pk_bf16_f32 v5, v38, v39
    v_mfma_f32_16x16x32_bf16 v[48:51], v[74:77], v[8:11], v[48:51]
    v_cvt_pk_bf16_f32 v6, v40, v41
    v_cvt_pk_bf16_f32 v7, v42, v43
    v_mfma_f32_16x16x32_bf16 v[36:39], v[70:73], v[12:15], 0
    ds_read_b64_tr_b16 v[180:181], v236 offset:0
    ds_read_b64_tr_b16 v[182:183], v236 offset:4096
    v_mfma_f32_16x16x32_bf16 v[36:39], v[76:79], v[12:15], v[36:39]
    ds_read_b64_tr_b16 v[184:185], v237 offset:0
    v_fma_f32 v114, v114, s36, v228
    v_mfma_f32_16x16x32_bf16 v[40:43], v[68:71], v[12:15], 0
    v_cvt_pk_bf16_f32 v8, v44, v45
    v_cvt_pk_bf16_f32 v9, v46, v47
    v_mfma_f32_16x16x32_bf16 v[40:43], v[74:77], v[12:15], v[40:43]
    v_cvt_pk_bf16_f32 v10, v48, v49
    v_cvt_pk_bf16_f32 v11, v50, v51
    v_mfma_f32_16x16x32_bf16 v[44:47], v[70:73], v[16:19], 0
    ds_read_b64_tr_b16 v[186:187], v237 offset:4096
    v_exp_f32 v113, v113
    v_mfma_f32_16x16x32_bf16 v[44:47], v[76:79], v[16:19], v[44:47]
    ds_read_b64_tr_b16 v[188:189], v238 offset:0
    v_fma_f32 v115, v115, s36, v228
    v_mfma_f32_16x16x32_bf16 v[48:51], v[68:71], v[16:19], 0
    v_cvt_pk_bf16_f32 v12, v36, v37
    v_cvt_pk_bf16_f32 v13, v38, v39
    v_mfma_f32_16x16x32_bf16 v[48:51], v[74:77], v[16:19], v[48:51]
    v_cvt_pk_bf16_f32 v14, v40, v41
    v_cvt_pk_bf16_f32 v15, v42, v43
    v_mfma_f32_16x16x32_bf16 v[36:39], v[70:73], v[20:23], 0
    ds_read_b64_tr_b16 v[190:191], v238 offset:4096
    v_exp_f32 v114, v114
    v_mfma_f32_16x16x32_bf16 v[36:39], v[76:79], v[20:23], v[36:39]
    ds_read_b64_tr_b16 v[192:193], v239 offset:0
    v_cvt_pk_bf16_f32 v142, v112, v113
    v_mfma_f32_16x16x32_bf16 v[40:43], v[68:71], v[20:23], 0
    v_cvt_pk_bf16_f32 v16, v44, v45
    v_cvt_pk_bf16_f32 v17, v46, v47
    v_mfma_f32_16x16x32_bf16 v[40:43], v[74:77], v[20:23], v[40:43]
    v_cvt_pk_bf16_f32 v18, v48, v49
    v_cvt_pk_bf16_f32 v19, v50, v51
    v_mfma_f32_16x16x32_bf16 v[44:47], v[70:73], v[24:27], 0
    ds_read_b64_tr_b16 v[194:195], v239 offset:4096
    v_fma_f32 v116, v116, s36, v224
    v_mfma_f32_16x16x32_bf16 v[44:47], v[76:79], v[24:27], v[44:47]
    ds_read_b64_tr_b16 v[196:197], v240 offset:0
    v_exp_f32 v115, v115
    v_mfma_f32_16x16x32_bf16 v[48:51], v[68:71], v[24:27], 0
    v_cvt_pk_bf16_f32 v20, v36, v37
    v_cvt_pk_bf16_f32 v21, v38, v39
    v_mfma_f32_16x16x32_bf16 v[48:51], v[74:77], v[24:27], v[48:51]
    v_cvt_pk_bf16_f32 v22, v40, v41
    v_cvt_pk_bf16_f32 v23, v42, v43
    v_mfma_f32_16x16x32_bf16 v[36:39], v[70:73], v[28:31], 0
    ds_read_b64_tr_b16 v[198:199], v240 offset:4096
    v_mov_b32 v225, v224
    v_mfma_f32_16x16x32_bf16 v[36:39], v[76:79], v[28:31], v[36:39]
    ds_read_b64_tr_b16 v[200:201], v241 offset:0
    v_mov_b32 v226, v224
    v_mfma_f32_16x16x32_bf16 v[40:43], v[68:71], v[28:31], 0
    v_cvt_pk_bf16_f32 v24, v44, v45
    v_cvt_pk_bf16_f32 v25, v46, v47
    v_mfma_f32_16x16x32_bf16 v[40:43], v[74:77], v[28:31], v[40:43]
    v_cvt_pk_bf16_f32 v26, v48, v49
    v_cvt_pk_bf16_f32 v27, v50, v51
    v_mfma_f32_16x16x32_bf16 v[44:47], v[70:73], v[32:35], 0
    v_mov_b32 v227, v224
    v_mfma_f32_16x16x32_bf16 v[44:47], v[76:79], v[32:35], v[44:47]
    v_mov_b32 v229, v228
    v_mfma_f32_16x16x32_bf16 v[48:51], v[68:71], v[32:35], 0
    v_cvt_pk_bf16_f32 v28, v36, v37
    v_cvt_pk_bf16_f32 v29, v38, v39
    v_mfma_f32_16x16x32_bf16 v[48:51], v[74:77], v[32:35], v[48:51]
    v_cvt_pk_bf16_f32 v30, v40, v41
    v_cvt_pk_bf16_f32 v31, v42, v43
    s_nop 3
    v_cvt_pk_bf16_f32 v32, v44, v45
    v_cvt_pk_bf16_f32 v33, v46, v47
    v_cvt_pk_bf16_f32 v34, v48, v49
    v_cvt_pk_bf16_f32 v35, v50, v51
    v_mov_b32 v230, v228
    v_mov_b32 v231, v228
    s_waitcnt lgkmcnt(11)
    v_mfma_f32_16x16x32_bf16 v[100:103], v[148:151], v[4:7], v[224:227]
    v_exp_f32 v116, v116
    v_mfma_f32_16x16x32_bf16 v[100:103], v[152:155], v[8:11], v[100:103]
    ds_read_b64_tr_b16 v[202:203], v241 offset:4096
    v_fma_f32 v117, v117, s36, v224
    v_cvt_pk_bf16_f32 v143, v114, v115
    v_mfma_f32_16x16x32_bf16 v[100:103], v[156:159], v[12:15], v[100:103]
    v_exp_f32 v117, v117
    v_mfma_f32_16x16x32_bf16 v[100:103], v[160:163], v[16:19], v[100:103]
    ds_read_b64_tr_b16 v[204:205], v242 offset:0
    ds_read_b64_tr_b16 v[206:207], v242 offset:4096
    v_fma_f32 v118, v118, s36, v224
    v_mfma_f32_16x16x32_bf16 v[108:111], v[148:151], v[20:23], v[228:231]
    v_exp_f32 v118, v118
    v_mfma_f32_16x16x32_bf16 v[108:111], v[152:155], v[24:27], v[108:111]
    ds_read_b64_tr_b16 v[208:209], v243 offset:0
    v_fma_f32 v119, v119, s36, v224
    v_cvt_pk_bf16_f32 v136, v116, v117
    v_mfma_f32_16x16x32_bf16 v[108:111], v[156:159], v[28:31], v[108:111]
    v_exp_f32 v119, v119
    v_mfma_f32_16x16x32_bf16 v[108:111], v[160:163], v[32:35], v[108:111]
    ds_read_b64_tr_b16 v[210:211], v243 offset:4096
    ds_read_b128 v[148:151], v232 offset:24576
    v_fma_f32 v120, v120, s36, v224
    v_mfma_f32_16x16x32_bf16 v[104:107], v[164:167], v[4:7], v[224:227]
    v_exp_f32 v120, v120
    v_mfma_f32_16x16x32_bf16 v[104:107], v[168:171], v[8:11], v[104:107]
    ds_read_b128 v[152:155], v233 offset:24576
    v_fma_f32 v121, v121, s36, v224
    v_cvt_pk_bf16_f32 v137, v118, v119
    v_mfma_f32_16x16x32_bf16 v[104:107], v[172:175], v[12:15], v[104:107]
    v_exp_f32 v121, v121
    v_mfma_f32_16x16x32_bf16 v[104:107], v[176:179], v[16:19], v[104:107]
    ds_read_b128 v[156:159], v234 offset:24576
    ds_read_b128 v[160:163], v235 offset:24576
    v_fma_f32 v122, v122, s36, v224
    v_mfma_f32_16x16x32_bf16 v[112:115], v[164:167], v[20:23], v[228:231]
    v_exp_f32 v122, v122
    v_mfma_f32_16x16x32_bf16 v[112:115], v[168:171], v[24:27], v[112:115]
    ds_read_b128 v[164:167], v232 offset:28672
    v_fma_f32 v123, v123, s36, v224
    v_cvt_pk_bf16_f32 v138, v120, v121
    v_mfma_f32_16x16x32_bf16 v[112:115], v[172:175], v[28:31], v[112:115]
    v_exp_f32 v123, v123
    v_mfma_f32_16x16x32_bf16 v[112:115], v[176:179], v[32:35], v[112:115]
    ds_read_b128 v[168:171], v233 offset:28672
    ds_read_b128 v[172:175], v234 offset:28672
    v_fma_f32 v124, v124, s36, v228
    s_waitcnt lgkmcnt(7)
    v_mfma_f32_16x16x32_bf16 v[36:39], v[180:183], v[132:135], 0
    v_exp_f32 v124, v124
    v_mfma_f32_16x16x32_bf16 v[40:43], v[180:183], v[140:143], 0
    ds_read_b128 v[176:179], v235 offset:28672
    v_fma_f32 v125, v125, s36, v228
    v_cvt_pk_bf16_f32 v139, v122, v123
    v_mfma_f32_16x16x32_bf16 v[44:47], v[184:187], v[132:135], 0
    v_exp_f32 v125, v125
    v_mfma_f32_16x16x32_bf16 v[48:51], v[184:187], v[140:143], 0
    ds_read_b64_tr_b16 v[180:181], v236 offset:8192
    ds_read_b64_tr_b16 v[182:183], v236 offset:12288
    v_fma_f32 v126, v126, s36, v228
    v_mfma_f32_16x16x32_bf16 v[52:55], v[188:191], v[132:135], 0
    v_exp_f32 v126, v126
    v_mfma_f32_16x16x32_bf16 v[56:59], v[188:191], v[140:143], 0
    ds_read_b64_tr_b16 v[184:185], v237 offset:8192
    v_fma_f32 v127, v127, s36, v228
    v_cvt_pk_bf16_f32 v144, v124, v125
    v_mfma_f32_16x16x32_bf16 v[60:63], v[192:195], v[132:135], 0
    v_exp_f32 v127, v127
    v_mfma_f32_16x16x32_bf16 v[64:67], v[192:195], v[140:143], 0
    ds_read_b64_tr_b16 v[186:187], v237 offset:12288
    ds_read_b64_tr_b16 v[188:189], v238 offset:8192
    v_fma_f32 v128, v128, s36, v228
    v_mfma_f32_16x16x32_bf16 v[68:71], v[196:199], v[132:135], 0
    v_exp_f32 v128, v128
    v_mfma_f32_16x16x32_bf16 v[72:75], v[196:199], v[140:143], 0
    ds_read_b64_tr_b16 v[190:191], v238 offset:12288
    v_fma_f32 v129, v129, s36, v228
    v_cvt_pk_bf16_f32 v145, v126, v127
    v_mfma_f32_16x16x32_bf16 v[76:79], v[200:203], v[132:135], 0
    v_exp_f32 v129, v129
    v_mfma_f32_16x16x32_bf16 v[80:83], v[200:203], v[140:143], 0
    ds_read_b64_tr_b16 v[192:193], v239 offset:8192
    ds_read_b64_tr_b16 v[194:195], v239 offset:12288
    v_fma_f32 v130, v130, s36, v228
    v_mfma_f32_16x16x32_bf16 v[84:87], v[204:207], v[132:135], 0
    v_exp_f32 v130, v130
    v_mfma_f32_16x16x32_bf16 v[88:91], v[204:207], v[140:143], 0
    ds_read_b64_tr_b16 v[196:197], v240 offset:8192
    v_fma_f32 v131, v131, s36, v228
    v_cvt_pk_bf16_f32 v146, v128, v129
    v_mfma_f32_16x16x32_bf16 v[92:95], v[208:211], v[132:135], 0
    v_exp_f32 v131, v131
    v_mfma_f32_16x16x32_bf16 v[96:99], v[208:211], v[140:143], 0
    ds_read_b64_tr_b16 v[198:199], v240 offset:12288
    ds_read_b64_tr_b16 v[200:201], v241 offset:8192
    v_smfmac_f32_16x16x64_bf16 v[212:215], v[220:223], v[132:139], v253
    s_waitcnt lgkmcnt(11)
    v_mfma_f32_16x16x32_bf16 v[116:119], v[148:151], v[4:7], v[224:227]
    v_exp_f32 v100, v100
    v_mfma_f32_16x16x32_bf16 v[116:119], v[152:155], v[8:11], v[116:119]
    ds_read_b64_tr_b16 v[202:203], v241 offset:12288
    v_cvt_pk_bf16_f32 v147, v130, v131
    v_mfma_f32_16x16x32_bf16 v[116:119], v[156:159], v[12:15], v[116:119]
    v_exp_f32 v101, v101
    v_mfma_f32_16x16x32_bf16 v[116:119], v[160:163], v[16:19], v[116:119]
    ds_read_b64_tr_b16 v[204:205], v242 offset:8192
    ds_read_b64_tr_b16 v[206:207], v242 offset:12288
    v_mfma_f32_16x16x32_bf16 v[124:127], v[148:151], v[20:23], v[228:231]
    v_exp_f32 v102, v102
    v_mfma_f32_16x16x32_bf16 v[124:127], v[152:155], v[24:27], v[124:127]
    ds_read_b64_tr_b16 v[208:209], v243 offset:8192
    ds_read_b64_tr_b16 v[210:211], v243 offset:12288
    v_mfma_f32_16x16x32_bf16 v[124:127], v[156:159], v[28:31], v[124:127]
    v_exp_f32 v103, v103
    v_mfma_f32_16x16x32_bf16 v[124:127], v[160:163], v[32:35], v[124:127]
    v_cvt_pk_bf16_f32 v132, v100, v101
    v_cvt_pk_bf16_f32 v133, v102, v103
    v_mfma_f32_16x16x32_bf16 v[120:123], v[164:167], v[4:7], v[224:227]
    v_exp_f32 v104, v104
    v_mfma_f32_16x16x32_bf16 v[120:123], v[168:171], v[8:11], v[120:123]
    s_waitcnt lgkmcnt(0)
    s_barrier
    ds_read_b128 v[148:151], v232 offset:32768
    v_mfma_f32_16x16x32_bf16 v[120:123], v[172:175], v[12:15], v[120:123]
    v_exp_f32 v105, v105
    v_mfma_f32_16x16x32_bf16 v[120:123], v[176:179], v[16:19], v[120:123]
    ds_read_b128 v[152:155], v233 offset:32768
    ds_read_b128 v[156:159], v234 offset:32768
    v_mfma_f32_16x16x32_bf16 v[128:131], v[164:167], v[20:23], v[228:231]
    v_exp_f32 v106, v106
    v_mfma_f32_16x16x32_bf16 v[128:131], v[168:171], v[24:27], v[128:131]
    ds_read_b128 v[160:163], v235 offset:32768
    v_cvt_pk_bf16_f32 v134, v104, v105
    v_mfma_f32_16x16x32_bf16 v[128:131], v[172:175], v[28:31], v[128:131]
    v_exp_f32 v107, v107
    v_mfma_f32_16x16x32_bf16 v[128:131], v[176:179], v[32:35], v[128:131]
    ds_read_b128 v[164:167], v232 offset:36864
    ds_read_b128 v[168:171], v233 offset:36864
    v_smfmac_f32_16x16x64_bf16 v[216:219], v[220:223], v[140:147], v253
    s_waitcnt lgkmcnt(6)
    v_mfma_f32_16x16x32_bf16 v[36:39], v[180:183], v[136:139], v[36:39]
    v_exp_f32 v108, v108
    v_mfma_f32_16x16x32_bf16 v[40:43], v[180:183], v[144:147], v[40:43]
    ds_read_b128 v[172:175], v234 offset:36864
    v_cvt_pk_bf16_f32 v135, v106, v107
    v_mfma_f32_16x16x32_bf16 v[44:47], v[184:187], v[136:139], v[44:47]
    v_exp_f32 v109, v109
    v_mfma_f32_16x16x32_bf16 v[48:51], v[184:187], v[144:147], v[48:51]
    ds_read_b128 v[176:179], v235 offset:36864
    ds_read_b64_tr_b16 v[180:181], v236 offset:16384
    v_mfma_f32_16x16x32_bf16 v[52:55], v[188:191], v[136:139], v[52:55]
    v_exp_f32 v110, v110
    v_mfma_f32_16x16x32_bf16 v[56:59], v[188:191], v[144:147], v[56:59]
    ds_read_b64_tr_b16 v[182:183], v236 offset:20480
    v_cvt_pk_bf16_f32 v140, v108, v109
    v_mfma_f32_16x16x32_bf16 v[60:63], v[192:195], v[136:139], v[60:63]
    v_exp_f32 v111, v111
    v_mfma_f32_16x16x32_bf16 v[64:67], v[192:195], v[144:147], v[64:67]
    ds_read_b64_tr_b16 v[184:185], v237 offset:16384
    ds_read_b64_tr_b16 v[186:187], v237 offset:20480
    v_mfma_f32_16x16x32_bf16 v[68:71], v[196:199], v[136:139], v[68:71]
    v_exp_f32 v112, v112
    v_mfma_f32_16x16x32_bf16 v[72:75], v[196:199], v[144:147], v[72:75]
    ds_read_b64_tr_b16 v[188:189], v238 offset:16384
    v_cvt_pk_bf16_f32 v141, v110, v111
    v_mfma_f32_16x16x32_bf16 v[76:79], v[200:203], v[136:139], v[76:79]
    v_exp_f32 v113, v113
    v_mfma_f32_16x16x32_bf16 v[80:83], v[200:203], v[144:147], v[80:83]
    ds_read_b64_tr_b16 v[190:191], v238 offset:20480
    ds_read_b64_tr_b16 v[192:193], v239 offset:16384
    v_mfma_f32_16x16x32_bf16 v[84:87], v[204:207], v[136:139], v[84:87]
    v_exp_f32 v114, v114
    v_mfma_f32_16x16x32_bf16 v[88:91], v[204:207], v[144:147], v[88:91]
    ds_read_b64_tr_b16 v[194:195], v239 offset:20480
    v_cvt_pk_bf16_f32 v142, v112, v113
    v_mfma_f32_16x16x32_bf16 v[92:95], v[208:211], v[136:139], v[92:95]
    v_exp_f32 v115, v115
    v_mfma_f32_16x16x32_bf16 v[96:99], v[208:211], v[144:147], v[96:99]
    ds_read_b64_tr_b16 v[196:197], v240 offset:16384
    ds_read_b64_tr_b16 v[198:199], v240 offset:20480
    ds_read_b64_tr_b16 v[200:201], v241 offset:16384
    s_waitcnt lgkmcnt(11)
    v_mfma_f32_16x16x32_bf16 v[100:103], v[148:151], v[4:7], v[224:227]
    v_exp_f32 v116, v116
    v_mfma_f32_16x16x32_bf16 v[100:103], v[152:155], v[8:11], v[100:103]
    ds_read_b64_tr_b16 v[202:203], v241 offset:20480
    v_cvt_pk_bf16_f32 v143, v114, v115
    v_mfma_f32_16x16x32_bf16 v[100:103], v[156:159], v[12:15], v[100:103]
    v_exp_f32 v117, v117
    v_mfma_f32_16x16x32_bf16 v[100:103], v[160:163], v[16:19], v[100:103]
    ds_read_b64_tr_b16 v[204:205], v242 offset:16384
    ds_read_b64_tr_b16 v[206:207], v242 offset:20480
    v_mfma_f32_16x16x32_bf16 v[108:111], v[148:151], v[20:23], v[228:231]
    v_exp_f32 v118, v118
    v_mfma_f32_16x16x32_bf16 v[108:111], v[152:155], v[24:27], v[108:111]
    ds_read_b64_tr_b16 v[208:209], v243 offset:16384
    v_cvt_pk_bf16_f32 v136, v116, v117
    v_mfma_f32_16x16x32_bf16 v[108:111], v[156:159], v[28:31], v[108:111]
    v_exp_f32 v119, v119
    v_mfma_f32_16x16x32_bf16 v[108:111], v[160:163], v[32:35], v[108:111]
    ds_read_b64_tr_b16 v[210:211], v243 offset:20480
    ds_read_b128 v[148:151], v232 offset:40960
    v_mfma_f32_16x16x32_bf16 v[104:107], v[164:167], v[4:7], v[224:227]
    v_exp_f32 v120, v120
    v_mfma_f32_16x16x32_bf16 v[104:107], v[168:171], v[8:11], v[104:107]
    ds_read_b128 v[152:155], v233 offset:40960
    v_cvt_pk_bf16_f32 v137, v118, v119
    v_mfma_f32_16x16x32_bf16 v[104:107], v[172:175], v[12:15], v[104:107]
    v_exp_f32 v121, v121
    v_mfma_f32_16x16x32_bf16 v[104:107], v[176:179], v[16:19], v[104:107]
    ds_read_b128 v[156:159], v234 offset:40960
    ds_read_b128 v[160:163], v235 offset:40960
    v_mfma_f32_16x16x32_bf16 v[112:115], v[164:167], v[20:23], v[228:231]
    v_exp_f32 v122, v122
    v_mfma_f32_16x16x32_bf16 v[112:115], v[168:171], v[24:27], v[112:115]
    ds_read_b128 v[164:167], v232 offset:45056
    v_cvt_pk_bf16_f32 v138, v120, v121
    v_mfma_f32_16x16x32_bf16 v[112:115], v[172:175], v[28:31], v[112:115]
    v_exp_f32 v123, v123
    v_mfma_f32_16x16x32_bf16 v[112:115], v[176:179], v[32:35], v[112:115]
    ds_read_b128 v[168:171], v233 offset:45056
    ds_read_b128 v[172:175], v234 offset:45056
    s_waitcnt lgkmcnt(7)
    v_mfma_f32_16x16x32_bf16 v[36:39], v[180:183], v[132:135], v[36:39]
    v_exp_f32 v124, v124
    v_mfma_f32_16x16x32_bf16 v[40:43], v[180:183], v[140:143], v[40:43]
    ds_read_b128 v[176:179], v235 offset:45056
    v_cvt_pk_bf16_f32 v139, v122, v123
    v_mfma_f32_16x16x32_bf16 v[44:47], v[184:187], v[132:135], v[44:47]
    v_exp_f32 v125, v125
    v_mfma_f32_16x16x32_bf16 v[48:51], v[184:187], v[140:143], v[48:51]
    ds_read_b64_tr_b16 v[180:181], v236 offset:24576
    ds_read_b64_tr_b16 v[182:183], v236 offset:28672
    v_mfma_f32_16x16x32_bf16 v[52:55], v[188:191], v[132:135], v[52:55]
    v_exp_f32 v126, v126
    v_mfma_f32_16x16x32_bf16 v[56:59], v[188:191], v[140:143], v[56:59]
    ds_read_b64_tr_b16 v[184:185], v237 offset:24576
    v_cvt_pk_bf16_f32 v144, v124, v125
    v_mfma_f32_16x16x32_bf16 v[60:63], v[192:195], v[132:135], v[60:63]
    v_exp_f32 v127, v127
    v_mfma_f32_16x16x32_bf16 v[64:67], v[192:195], v[140:143], v[64:67]
    ds_read_b64_tr_b16 v[186:187], v237 offset:28672
    ds_read_b64_tr_b16 v[188:189], v238 offset:24576
    v_mfma_f32_16x16x32_bf16 v[68:71], v[196:199], v[132:135], v[68:71]
    v_exp_f32 v128, v128
    v_mfma_f32_16x16x32_bf16 v[72:75], v[196:199], v[140:143], v[72:75]
    ds_read_b64_tr_b16 v[190:191], v238 offset:28672
    v_cvt_pk_bf16_f32 v145, v126, v127
    v_mfma_f32_16x16x32_bf16 v[76:79], v[200:203], v[132:135], v[76:79]
    v_exp_f32 v129, v129
    v_mfma_f32_16x16x32_bf16 v[80:83], v[200:203], v[140:143], v[80:83]
    ds_read_b64_tr_b16 v[192:193], v239 offset:24576
    ds_read_b64_tr_b16 v[194:195], v239 offset:28672
    v_mfma_f32_16x16x32_bf16 v[84:87], v[204:207], v[132:135], v[84:87]
    v_exp_f32 v130, v130
    v_mfma_f32_16x16x32_bf16 v[88:91], v[204:207], v[140:143], v[88:91]
    ds_read_b64_tr_b16 v[196:197], v240 offset:24576
    v_cvt_pk_bf16_f32 v146, v128, v129
    v_mfma_f32_16x16x32_bf16 v[92:95], v[208:211], v[132:135], v[92:95]
    v_exp_f32 v131, v131
    v_mfma_f32_16x16x32_bf16 v[96:99], v[208:211], v[140:143], v[96:99]
    ds_read_b64_tr_b16 v[198:199], v240 offset:28672
    ds_read_b64_tr_b16 v[200:201], v241 offset:24576
    v_smfmac_f32_16x16x64_bf16 v[212:215], v[220:223], v[132:139], v253
    s_waitcnt lgkmcnt(11)
    v_mfma_f32_16x16x32_bf16 v[116:119], v[148:151], v[4:7], v[224:227]
    v_exp_f32 v100, v100
    v_mfma_f32_16x16x32_bf16 v[116:119], v[152:155], v[8:11], v[116:119]
    ds_read_b64_tr_b16 v[202:203], v241 offset:28672
    v_cvt_pk_bf16_f32 v147, v130, v131
    v_mfma_f32_16x16x32_bf16 v[116:119], v[156:159], v[12:15], v[116:119]
    v_exp_f32 v101, v101
    v_mfma_f32_16x16x32_bf16 v[116:119], v[160:163], v[16:19], v[116:119]
    ds_read_b64_tr_b16 v[204:205], v242 offset:24576
    ds_read_b64_tr_b16 v[206:207], v242 offset:28672
    v_mfma_f32_16x16x32_bf16 v[124:127], v[148:151], v[20:23], v[228:231]
    v_exp_f32 v102, v102
    v_mfma_f32_16x16x32_bf16 v[124:127], v[152:155], v[24:27], v[124:127]
    ds_read_b64_tr_b16 v[208:209], v243 offset:24576
    ds_read_b64_tr_b16 v[210:211], v243 offset:28672
    v_mfma_f32_16x16x32_bf16 v[124:127], v[156:159], v[28:31], v[124:127]
    v_exp_f32 v103, v103
    v_mfma_f32_16x16x32_bf16 v[124:127], v[160:163], v[32:35], v[124:127]
    v_cvt_pk_bf16_f32 v132, v100, v101
    v_cvt_pk_bf16_f32 v133, v102, v103
    v_mfma_f32_16x16x32_bf16 v[120:123], v[164:167], v[4:7], v[224:227]
    v_exp_f32 v104, v104
    v_mfma_f32_16x16x32_bf16 v[120:123], v[168:171], v[8:11], v[120:123]
    s_waitcnt lgkmcnt(0)
    s_barrier
    ds_read_b128 v[148:151], v232 offset:49152
    v_mfma_f32_16x16x32_bf16 v[120:123], v[172:175], v[12:15], v[120:123]
    v_exp_f32 v105, v105
    v_mfma_f32_16x16x32_bf16 v[120:123], v[176:179], v[16:19], v[120:123]
    ds_read_b128 v[152:155], v233 offset:49152
    ds_read_b128 v[156:159], v234 offset:49152
    v_mfma_f32_16x16x32_bf16 v[128:131], v[164:167], v[20:23], v[228:231]
    v_exp_f32 v106, v106
    v_mfma_f32_16x16x32_bf16 v[128:131], v[168:171], v[24:27], v[128:131]
    ds_read_b128 v[160:163], v235 offset:49152
    v_cvt_pk_bf16_f32 v134, v104, v105
    v_mfma_f32_16x16x32_bf16 v[128:131], v[172:175], v[28:31], v[128:131]
    v_exp_f32 v107, v107
    v_mfma_f32_16x16x32_bf16 v[128:131], v[176:179], v[32:35], v[128:131]
    ds_read_b128 v[164:167], v232 offset:53248
    ds_read_b128 v[168:171], v233 offset:53248
    v_smfmac_f32_16x16x64_bf16 v[216:219], v[220:223], v[140:147], v253
    s_waitcnt lgkmcnt(6)
    v_mfma_f32_16x16x32_bf16 v[36:39], v[180:183], v[136:139], v[36:39]
    v_exp_f32 v108, v108
    v_mfma_f32_16x16x32_bf16 v[40:43], v[180:183], v[144:147], v[40:43]
    ds_read_b128 v[172:175], v234 offset:53248
    v_cvt_pk_bf16_f32 v135, v106, v107
    s_cbranch_vccnz L_nd_1
    s_add_u32 m0, s24, 0
    s_add_u32 s29, s38, 65536
    buffer_load_dwordx4 v244, s[8:11], s29 offen offset:0  lds
    buffer_load_dwordx4 v245, s[8:11], s29 offen offset:1024  lds
    buffer_load_dwordx4 v246, s[8:11], s29 offen offset:2048  lds
    buffer_load_dwordx4 v247, s[8:11], s29 offen offset:3072  lds
    s_add_u32 m0, s24, 114688
    s_add_u32 s29, s38, 49152
    buffer_load_dwordx4 v248, s[12:15], s29 offen offset:0  lds
    buffer_load_dwordx4 v249, s[12:15], s29 offen offset:1024  lds
    buffer_load_dwordx4 v248, s[12:15], s29 offen offset:2048  lds
    buffer_load_dwordx4 v249, s[12:15], s29 offen offset:3072  lds
L_nd_1:
    v_mfma_f32_16x16x32_bf16 v[44:47], v[184:187], v[136:139], v[44:47]
    v_exp_f32 v109, v109
    v_mfma_f32_16x16x32_bf16 v[48:51], v[184:187], v[144:147], v[48:51]
    ds_read_b128 v[176:179], v235 offset:53248
    ds_read_b64_tr_b16 v[180:181], v236 offset:32768
    v_mfma_f32_16x16x32_bf16 v[52:55], v[188:191], v[136:139], v[52:55]
    v_exp_f32 v110, v110
    v_mfma_f32_16x16x32_bf16 v[56:59], v[188:191], v[144:147], v[56:59]
    ds_read_b64_tr_b16 v[182:183], v236 offset:36864
    v_cvt_pk_bf16_f32 v140, v108, v109
    v_mfma_f32_16x16x32_bf16 v[60:63], v[192:195], v[136:139], v[60:63]
    v_exp_f32 v111, v111
    v_mfma_f32_16x16x32_bf16 v[64:67], v[192:195], v[144:147], v[64:67]
    ds_read_b64_tr_b16 v[184:185], v237 offset:32768
    ds_read_b64_tr_b16 v[186:187], v237 offset:36864
    v_mfma_f32_16x16x32_bf16 v[68:71], v[196:199], v[136:139], v[68:71]
    v_exp_f32 v112, v112
    v_mfma_f32_16x16x32_bf16 v[72:75], v[196:199], v[144:147], v[72:75]
    ds_read_b64_tr_b16 v[188:189], v238 offset:32768
    v_cvt_pk_bf16_f32 v141, v110, v111
    v_mfma_f32_16x16x32_bf16 v[76:79], v[200:203], v[136:139], v[76:79]
    v_exp_f32 v113, v113
    v_mfma_f32_16x16x32_bf16 v[80:83], v[200:203], v[144:147], v[80:83]
    ds_read_b64_tr_b16 v[190:191], v238 offset:36864
    ds_read_b64_tr_b16 v[192:193], v239 offset:32768
    v_mfma_f32_16x16x32_bf16 v[84:87], v[204:207], v[136:139], v[84:87]
    v_exp_f32 v114, v114
    v_mfma_f32_16x16x32_bf16 v[88:91], v[204:207], v[144:147], v[88:91]
    ds_read_b64_tr_b16 v[194:195], v239 offset:36864
    v_cvt_pk_bf16_f32 v142, v112, v113
    v_mfma_f32_16x16x32_bf16 v[92:95], v[208:211], v[136:139], v[92:95]
    v_exp_f32 v115, v115
    v_mfma_f32_16x16x32_bf16 v[96:99], v[208:211], v[144:147], v[96:99]
    ds_read_b64_tr_b16 v[196:197], v240 offset:32768
    ds_read_b64_tr_b16 v[198:199], v240 offset:36864
    ds_read_b64_tr_b16 v[200:201], v241 offset:32768
    s_waitcnt lgkmcnt(11)
    v_mfma_f32_16x16x32_bf16 v[100:103], v[148:151], v[4:7], v[224:227]
    v_exp_f32 v116, v116
    v_mfma_f32_16x16x32_bf16 v[100:103], v[152:155], v[8:11], v[100:103]
    ds_read_b64_tr_b16 v[202:203], v241 offset:36864
    v_cvt_pk_bf16_f32 v143, v114, v115
    v_mfma_f32_16x16x32_bf16 v[100:103], v[156:159], v[12:15], v[100:103]
    v_exp_f32 v117, v117
    v_mfma_f32_16x16x32_bf16 v[100:103], v[160:163], v[16:19], v[100:103]
    ds_read_b64_tr_b16 v[204:205], v242 offset:32768
    ds_read_b64_tr_b16 v[206:207], v242 offset:36864
    v_mfma_f32_16x16x32_bf16 v[108:111], v[148:151], v[20:23], v[228:231]
    v_exp_f32 v118, v118
    v_mfma_f32_16x16x32_bf16 v[108:111], v[152:155], v[24:27], v[108:111]
    ds_read_b64_tr_b16 v[208:209], v243 offset:32768
    v_cvt_pk_bf16_f32 v136, v116, v117
    v_mfma_f32_16x16x32_bf16 v[108:111], v[156:159], v[28:31], v[108:111]
    v_exp_f32 v119, v119
    v_mfma_f32_16x16x32_bf16 v[108:111], v[160:163], v[32:35], v[108:111]
    ds_read_b64_tr_b16 v[210:211], v243 offset:36864
    ds_read_b128 v[148:151], v232 offset:57344
    v_mfma_f32_16x16x32_bf16 v[104:107], v[164:167], v[4:7], v[224:227]
    v_exp_f32 v120, v120
    v_mfma_f32_16x16x32_bf16 v[104:107], v[168:171], v[8:11], v[104:107]
    ds_read_b128 v[152:155], v233 offset:57344
    v_cvt_pk_bf16_f32 v137, v118, v119
    v_mfma_f32_16x16x32_bf16 v[104:107], v[172:175], v[12:15], v[104:107]
    v_exp_f32 v121, v121
    v_mfma_f32_16x16x32_bf16 v[104:107], v[176:179], v[16:19], v[104:107]
    ds_read_b128 v[156:159], v234 offset:57344
    ds_read_b128 v[160:163], v235 offset:57344
    v_mfma_f32_16x16x32_bf16 v[112:115], v[164:167], v[20:23], v[228:231]
    v_exp_f32 v122, v122
    v_mfma_f32_16x16x32_bf16 v[112:115], v[168:171], v[24:27], v[112:115]
    ds_read_b128 v[164:167], v232 offset:61440
    v_cvt_pk_bf16_f32 v138, v120, v121
    v_mfma_f32_16x16x32_bf16 v[112:115], v[172:175], v[28:31], v[112:115]
    v_exp_f32 v123, v123
    v_mfma_f32_16x16x32_bf16 v[112:115], v[176:179], v[32:35], v[112:115]
    ds_read_b128 v[168:171], v233 offset:61440
    ds_read_b128 v[172:175], v234 offset:61440
    s_waitcnt lgkmcnt(7)
    v_mfma_f32_16x16x32_bf16 v[36:39], v[180:183], v[132:135], v[36:39]
    v_exp_f32 v124, v124
    v_mfma_f32_16x16x32_bf16 v[40:43], v[180:183], v[140:143], v[40:43]
    ds_read_b128 v[176:179], v235 offset:61440
    v_cvt_pk_bf16_f32 v139, v122, v123
    v_mfma_f32_16x16x32_bf16 v[44:47], v[184:187], v[132:135], v[44:47]
    v_exp_f32 v125, v125
    v_mfma_f32_16x16x32_bf16 v[48:51], v[184:187], v[140:143], v[48:51]
    ds_read_b64_tr_b16 v[180:181], v236 offset:40960
    ds_read_b64_tr_b16 v[182:183], v236 offset:45056
    v_mfma_f32_16x16x32_bf16 v[52:55], v[188:191], v[132:135], v[52:55]
    v_exp_f32 v126, v126
    v_mfma_f32_16x16x32_bf16 v[56:59], v[188:191], v[140:143], v[56:59]
    ds_read_b64_tr_b16 v[184:185], v237 offset:40960
    v_cvt_pk_bf16_f32 v144, v124, v125
    v_mfma_f32_16x16x32_bf16 v[60:63], v[192:195], v[132:135], v[60:63]
    v_exp_f32 v127, v127
    v_mfma_f32_16x16x32_bf16 v[64:67], v[192:195], v[140:143], v[64:67]
    ds_read_b64_tr_b16 v[186:187], v237 offset:45056
    ds_read_b64_tr_b16 v[188:189], v238 offset:40960
    v_mfma_f32_16x16x32_bf16 v[68:71], v[196:199], v[132:135], v[68:71]
    v_exp_f32 v128, v128
    v_mfma_f32_16x16x32_bf16 v[72:75], v[196:199], v[140:143], v[72:75]
    ds_read_b64_tr_b16 v[190:191], v238 offset:45056
    v_cvt_pk_bf16_f32 v145, v126, v127
    v_mfma_f32_16x16x32_bf16 v[76:79], v[200:203], v[132:135], v[76:79]
    v_exp_f32 v129, v129
    v_mfma_f32_16x16x32_bf16 v[80:83], v[200:203], v[140:143], v[80:83]
    ds_read_b64_tr_b16 v[192:193], v239 offset:40960
    ds_read_b64_tr_b16 v[194:195], v239 offset:45056
    v_mfma_f32_16x16x32_bf16 v[84:87], v[204:207], v[132:135], v[84:87]
    v_exp_f32 v130, v130
    v_mfma_f32_16x16x32_bf16 v[88:91], v[204:207], v[140:143], v[88:91]
    ds_read_b64_tr_b16 v[196:197], v240 offset:40960
    v_cvt_pk_bf16_f32 v146, v128, v129
    v_mfma_f32_16x16x32_bf16 v[92:95], v[208:211], v[132:135], v[92:95]
    v_exp_f32 v131, v131
    v_mfma_f32_16x16x32_bf16 v[96:99], v[208:211], v[140:143], v[96:99]
    ds_read_b64_tr_b16 v[198:199], v240 offset:45056
    ds_read_b64_tr_b16 v[200:201], v241 offset:40960
    v_smfmac_f32_16x16x64_bf16 v[212:215], v[220:223], v[132:139], v253
    s_waitcnt lgkmcnt(11)
    v_mfma_f32_16x16x32_bf16 v[116:119], v[148:151], v[4:7], v[224:227]
    v_exp_f32 v100, v100
    v_mfma_f32_16x16x32_bf16 v[116:119], v[152:155], v[8:11], v[116:119]
    ds_read_b64_tr_b16 v[202:203], v241 offset:45056
    v_cvt_pk_bf16_f32 v147, v130, v131
    v_mfma_f32_16x16x32_bf16 v[116:119], v[156:159], v[12:15], v[116:119]
    v_exp_f32 v101, v101
    v_mfma_f32_16x16x32_bf16 v[116:119], v[160:163], v[16:19], v[116:119]
    ds_read_b64_tr_b16 v[204:205], v242 offset:40960
    ds_read_b64_tr_b16 v[206:207], v242 offset:45056
    v_mfma_f32_16x16x32_bf16 v[124:127], v[148:151], v[20:23], v[228:231]
    v_exp_f32 v102, v102
    v_mfma_f32_16x16x32_bf16 v[124:127], v[152:155], v[24:27], v[124:127]
    ds_read_b64_tr_b16 v[208:209], v243 offset:40960
    ds_read_b64_tr_b16 v[210:211], v243 offset:45056
    v_mfma_f32_16x16x32_bf16 v[124:127], v[156:159], v[28:31], v[124:127]
    v_exp_f32 v103, v103
    v_mfma_f32_16x16x32_bf16 v[124:127], v[160:163], v[32:35], v[124:127]
    v_cvt_pk_bf16_f32 v132, v100, v101
    v_cvt_pk_bf16_f32 v133, v102, v103
    v_mfma_f32_16x16x32_bf16 v[120:123], v[164:167], v[4:7], v[224:227]
    v_exp_f32 v104, v104
    v_mfma_f32_16x16x32_bf16 v[120:123], v[168:171], v[8:11], v[120:123]
    s_waitcnt vmcnt(0) lgkmcnt(0)
    s_barrier
    ds_read_b128 v[148:151], v232 offset:0
    v_mfma_f32_16x16x32_bf16 v[120:123], v[172:175], v[12:15], v[120:123]
    v_exp_f32 v105, v105
    v_mfma_f32_16x16x32_bf16 v[120:123], v[176:179], v[16:19], v[120:123]
    ds_read_b128 v[152:155], v233 offset:0
    ds_read_b128 v[156:159], v234 offset:0
    v_mfma_f32_16x16x32_bf16 v[128:131], v[164:167], v[20:23], v[228:231]
    v_exp_f32 v106, v106
    v_mfma_f32_16x16x32_bf16 v[128:131], v[168:171], v[24:27], v[128:131]
    ds_read_b128 v[160:163], v235 offset:0
    v_cvt_pk_bf16_f32 v134, v104, v105
    v_mfma_f32_16x16x32_bf16 v[128:131], v[172:175], v[28:31], v[128:131]
    v_exp_f32 v107, v107
    v_mfma_f32_16x16x32_bf16 v[128:131], v[176:179], v[32:35], v[128:131]
    ds_read_b128 v[164:167], v232 offset:4096
    ds_read_b128 v[168:171], v233 offset:4096
    v_smfmac_f32_16x16x64_bf16 v[216:219], v[220:223], v[140:147], v253
    s_waitcnt lgkmcnt(6)
    v_mfma_f32_16x16x32_bf16 v[36:39], v[180:183], v[136:139], v[36:39]
    v_exp_f32 v108, v108
    v_mfma_f32_16x16x32_bf16 v[40:43], v[180:183], v[144:147], v[40:43]
    ds_read_b128 v[172:175], v234 offset:4096
    v_cvt_pk_bf16_f32 v135, v106, v107
    s_cbranch_vccnz L_nd_2
    s_add_u32 m0, s24, 16384
    s_add_u32 s29, s38, 81920
    buffer_load_dwordx4 v244, s[8:11], s29 offen offset:0  lds
    buffer_load_dwordx4 v245, s[8:11], s29 offen offset:1024  lds
    buffer_load_dwordx4 v246, s[8:11], s29 offen offset:2048  lds
    buffer_load_dwordx4 v247, s[8:11], s29 offen offset:3072  lds
    s_add_u32 m0, s24, 65536
    s_add_u32 s29, s38, 65536
    buffer_load_dwordx4 v248, s[12:15], s29 offen offset:0  lds
    buffer_load_dwordx4 v249, s[12:15], s29 offen offset:1024  lds
    buffer_load_dwordx4 v248, s[12:15], s29 offen offset:2048  lds
    buffer_load_dwordx4 v249, s[12:15], s29 offen offset:3072  lds
L_nd_2:
    v_mfma_f32_16x16x32_bf16 v[44:47], v[184:187], v[136:139], v[44:47]
    v_exp_f32 v109, v109
    v_mfma_f32_16x16x32_bf16 v[48:51], v[184:187], v[144:147], v[48:51]
    ds_read_b128 v[176:179], v235 offset:4096
    ds_read_b64_tr_b16 v[180:181], v236 offset:49152
    v_mfma_f32_16x16x32_bf16 v[52:55], v[188:191], v[136:139], v[52:55]
    v_exp_f32 v110, v110
    v_mfma_f32_16x16x32_bf16 v[56:59], v[188:191], v[144:147], v[56:59]
    ds_read_b64_tr_b16 v[182:183], v236 offset:53248
    v_cvt_pk_bf16_f32 v140, v108, v109
    v_mfma_f32_16x16x32_bf16 v[60:63], v[192:195], v[136:139], v[60:63]
    v_exp_f32 v111, v111
    v_mfma_f32_16x16x32_bf16 v[64:67], v[192:195], v[144:147], v[64:67]
    ds_read_b64_tr_b16 v[184:185], v237 offset:49152
    ds_read_b64_tr_b16 v[186:187], v237 offset:53248
    v_mfma_f32_16x16x32_bf16 v[68:71], v[196:199], v[136:139], v[68:71]
    v_exp_f32 v112, v112
    v_mfma_f32_16x16x32_bf16 v[72:75], v[196:199], v[144:147], v[72:75]
    ds_read_b64_tr_b16 v[188:189], v238 offset:49152
    v_cvt_pk_bf16_f32 v141, v110, v111
    v_mfma_f32_16x16x32_bf16 v[76:79], v[200:203], v[136:139], v[76:79]
    v_exp_f32 v113, v113
    v_mfma_f32_16x16x32_bf16 v[80:83], v[200:203], v[144:147], v[80:83]
    ds_read_b64_tr_b16 v[190:191], v238 offset:53248
    ds_read_b64_tr_b16 v[192:193], v239 offset:49152
    v_mfma_f32_16x16x32_bf16 v[84:87], v[204:207], v[136:139], v[84:87]
    v_exp_f32 v114, v114
    v_mfma_f32_16x16x32_bf16 v[88:91], v[204:207], v[144:147], v[88:91]
    ds_read_b64_tr_b16 v[194:195], v239 offset:53248
    v_cvt_pk_bf16_f32 v142, v112, v113
    v_mfma_f32_16x16x32_bf16 v[92:95], v[208:211], v[136:139], v[92:95]
    v_exp_f32 v115, v115
    v_mfma_f32_16x16x32_bf16 v[96:99], v[208:211], v[144:147], v[96:99]
    ds_read_b64_tr_b16 v[196:197], v240 offset:49152
    ds_read_b64_tr_b16 v[198:199], v240 offset:53248
    ds_read_b64_tr_b16 v[200:201], v241 offset:49152
    s_waitcnt lgkmcnt(11)
    v_mfma_f32_16x16x32_bf16 v[100:103], v[148:151], v[4:7], v[224:227]
    v_exp_f32 v116, v116
    v_mfma_f32_16x16x32_bf16 v[100:103], v[152:155], v[8:11], v[100:103]
    ds_read_b64_tr_b16 v[202:203], v241 offset:53248
    v_cvt_pk_bf16_f32 v143, v114, v115
    v_mfma_f32_16x16x32_bf16 v[100:103], v[156:159], v[12:15], v[100:103]
    v_exp_f32 v117, v117
    v_mfma_f32_16x16x32_bf16 v[100:103], v[160:163], v[16:19], v[100:103]
    ds_read_b64_tr_b16 v[204:205], v242 offset:49152
    ds_read_b64_tr_b16 v[206:207], v242 offset:53248
    v_mfma_f32_16x16x32_bf16 v[108:111], v[148:151], v[20:23], v[228:231]
    v_exp_f32 v118, v118
    v_mfma_f32_16x16x32_bf16 v[108:111], v[152:155], v[24:27], v[108:111]
    ds_read_b64_tr_b16 v[208:209], v243 offset:49152
    v_cvt_pk_bf16_f32 v136, v116, v117
    v_mfma_f32_16x16x32_bf16 v[108:111], v[156:159], v[28:31], v[108:111]
    v_exp_f32 v119, v119
    v_mfma_f32_16x16x32_bf16 v[108:111], v[160:163], v[32:35], v[108:111]
    ds_read_b64_tr_b16 v[210:211], v243 offset:53248
    ds_read_b128 v[148:151], v232 offset:8192
    v_mfma_f32_16x16x32_bf16 v[104:107], v[164:167], v[4:7], v[224:227]
    v_exp_f32 v120, v120
    v_mfma_f32_16x16x32_bf16 v[104:107], v[168:171], v[8:11], v[104:107]
    ds_read_b128 v[152:155], v233 offset:8192
    v_cvt_pk_bf16_f32 v137, v118, v119
    v_mfma_f32_16x16x32_bf16 v[104:107], v[172:175], v[12:15], v[104:107]
    v_exp_f32 v121, v121
    v_mfma_f32_16x16x32_bf16 v[104:107], v[176:179], v[16:19], v[104:107]
    ds_read_b128 v[156:159], v234 offset:8192
    ds_read_b128 v[160:163], v235 offset:8192
    v_mfma_f32_16x16x32_bf16 v[112:115], v[164:167], v[20:23], v[228:231]
    v_exp_f32 v122, v122
    v_mfma_f32_16x16x32_bf16 v[112:115], v[168:171], v[24:27], v[112:115]
    ds_read_b128 v[164:167], v232 offset:12288
    v_cvt_pk_bf16_f32 v138, v120, v121
    v_mfma_f32_16x16x32_bf16 v[112:115], v[172:175], v[28:31], v[112:115]
    v_exp_f32 v123, v123
    v_mfma_f32_16x16x32_bf16 v[112:115], v[176:179], v[32:35], v[112:115]
    ds_read_b128 v[168:171], v233 offset:12288
    ds_read_b128 v[172:175], v234 offset:12288
    s_waitcnt lgkmcnt(7)
    v_mfma_f32_16x16x32_bf16 v[36:39], v[180:183], v[132:135], v[36:39]
    v_exp_f32 v124, v124
    v_mfma_f32_16x16x32_bf16 v[40:43], v[180:183], v[140:143], v[40:43]
    ds_read_b128 v[176:179], v235 offset:12288
    v_cvt_pk_bf16_f32 v139, v122, v123
    v_mfma_f32_16x16x32_bf16 v[44:47], v[184:187], v[132:135], v[44:47]
    v_exp_f32 v125, v125
    v_mfma_f32_16x16x32_bf16 v[48:51], v[184:187], v[140:143], v[48:51]
    ds_read_b64_tr_b16 v[180:181], v236 offset:57344
    ds_read_b64_tr_b16 v[182:183], v236 offset:61440
    v_mfma_f32_16x16x32_bf16 v[52:55], v[188:191], v[132:135], v[52:55]
    v_exp_f32 v126, v126
    v_mfma_f32_16x16x32_bf16 v[56:59], v[188:191], v[140:143], v[56:59]
    ds_read_b64_tr_b16 v[184:185], v237 offset:57344
    v_cvt_pk_bf16_f32 v144, v124, v125
    v_mfma_f32_16x16x32_bf16 v[60:63], v[192:195], v[132:135], v[60:63]
    v_exp_f32 v127, v127
    v_mfma_f32_16x16x32_bf16 v[64:67], v[192:195], v[140:143], v[64:67]
    ds_read_b64_tr_b16 v[186:187], v237 offset:61440
    ds_read_b64_tr_b16 v[188:189], v238 offset:57344
    v_mfma_f32_16x16x32_bf16 v[68:71], v[196:199], v[132:135], v[68:71]
    v_exp_f32 v128, v128
    v_mfma_f32_16x16x32_bf16 v[72:75], v[196:199], v[140:143], v[72:75]
    ds_read_b64_tr_b16 v[190:191], v238 offset:61440
    v_cvt_pk_bf16_f32 v145, v126, v127
    v_mfma_f32_16x16x32_bf16 v[76:79], v[200:203], v[132:135], v[76:79]
    v_exp_f32 v129, v129
    v_mfma_f32_16x16x32_bf16 v[80:83], v[200:203], v[140:143], v[80:83]
    ds_read_b64_tr_b16 v[192:193], v239 offset:57344
    ds_read_b64_tr_b16 v[194:195], v239 offset:61440
    v_mfma_f32_16x16x32_bf16 v[84:87], v[204:207], v[132:135], v[84:87]
    v_exp_f32 v130, v130
    v_mfma_f32_16x16x32_bf16 v[88:91], v[204:207], v[140:143], v[88:91]
    ds_read_b64_tr_b16 v[196:197], v240 offset:57344
    v_cvt_pk_bf16_f32 v146, v128, v129
    v_mfma_f32_16x16x32_bf16 v[92:95], v[208:211], v[132:135], v[92:95]
    v_exp_f32 v131, v131
    v_mfma_f32_16x16x32_bf16 v[96:99], v[208:211], v[140:143], v[96:99]
    ds_read_b64_tr_b16 v[198:199], v240 offset:61440
    ds_read_b64_tr_b16 v[200:201], v241 offset:57344
    v_smfmac_f32_16x16x64_bf16 v[212:215], v[220:223], v[132:139], v253
    s_waitcnt lgkmcnt(11)
    v_mfma_f32_16x16x32_bf16 v[116:119], v[148:151], v[4:7], v[224:227]
    v_exp_f32 v100, v100
    v_mfma_f32_16x16x32_bf16 v[116:119], v[152:155], v[8:11], v[116:119]
    ds_read_b64_tr_b16 v[202:203], v241 offset:61440
    v_cvt_pk_bf16_f32 v147, v130, v131
    v_mfma_f32_16x16x32_bf16 v[116:119], v[156:159], v[12:15], v[116:119]
    v_exp_f32 v101, v101
    v_mfma_f32_16x16x32_bf16 v[116:119], v[160:163], v[16:19], v[116:119]
    ds_read_b64_tr_b16 v[204:205], v242 offset:57344
    ds_read_b64_tr_b16 v[206:207], v242 offset:61440
    v_mfma_f32_16x16x32_bf16 v[124:127], v[148:151], v[20:23], v[228:231]
    v_exp_f32 v102, v102
    v_mfma_f32_16x16x32_bf16 v[124:127], v[152:155], v[24:27], v[124:127]
    ds_read_b64_tr_b16 v[208:209], v243 offset:57344
    ds_read_b64_tr_b16 v[210:211], v243 offset:61440
    v_mfma_f32_16x16x32_bf16 v[124:127], v[156:159], v[28:31], v[124:127]
    v_exp_f32 v103, v103
    v_mfma_f32_16x16x32_bf16 v[124:127], v[160:163], v[32:35], v[124:127]
    v_cvt_pk_bf16_f32 v132, v100, v101
    v_cvt_pk_bf16_f32 v133, v102, v103
    v_mfma_f32_16x16x32_bf16 v[120:123], v[164:167], v[4:7], v[224:227]
    v_exp_f32 v104, v104
    v_mfma_f32_16x16x32_bf16 v[120:123], v[168:171], v[8:11], v[120:123]
    s_waitcnt vmcnt(0) lgkmcnt(0)
    s_barrier
    ds_read_b128 v[148:151], v232 offset:16384
    v_mfma_f32_16x16x32_bf16 v[120:123], v[172:175], v[12:15], v[120:123]
    v_exp_f32 v105, v105
    v_mfma_f32_16x16x32_bf16 v[120:123], v[176:179], v[16:19], v[120:123]
    ds_read_b128 v[152:155], v233 offset:16384
    ds_read_b128 v[156:159], v234 offset:16384
    v_mfma_f32_16x16x32_bf16 v[128:131], v[164:167], v[20:23], v[228:231]
    v_exp_f32 v106, v106
    v_mfma_f32_16x16x32_bf16 v[128:131], v[168:171], v[24:27], v[128:131]
    ds_read_b128 v[160:163], v235 offset:16384
    v_cvt_pk_bf16_f32 v134, v104, v105
    v_mfma_f32_16x16x32_bf16 v[128:131], v[172:175], v[28:31], v[128:131]
    v_exp_f32 v107, v107
    v_mfma_f32_16x16x32_bf16 v[128:131], v[176:179], v[32:35], v[128:131]
    ds_read_b128 v[164:167], v232 offset:20480
    ds_read_b128 v[168:171], v233 offset:20480
    v_smfmac_f32_16x16x64_bf16 v[216:219], v[220:223], v[140:147], v253
    s_waitcnt lgkmcnt(6)
    v_mfma_f32_16x16x32_bf16 v[36:39], v[180:183], v[136:139], v[36:39]
    v_exp_f32 v108, v108
    v_mfma_f32_16x16x32_bf16 v[40:43], v[180:183], v[144:147], v[40:43]
    ds_read_b128 v[172:175], v234 offset:20480
    v_cvt_pk_bf16_f32 v135, v106, v107
    s_cbranch_vccnz L_nd_3
    s_add_u32 m0, s24, 32768
    s_add_u32 s29, s38, 98304
    buffer_load_dwordx4 v244, s[8:11], s29 offen offset:0  lds
    buffer_load_dwordx4 v245, s[8:11], s29 offen offset:1024  lds
    buffer_load_dwordx4 v246, s[8:11], s29 offen offset:2048  lds
    buffer_load_dwordx4 v247, s[8:11], s29 offen offset:3072  lds
    s_add_u32 m0, s24, 81920
    s_add_u32 s29, s38, 81920
    buffer_load_dwordx4 v248, s[12:15], s29 offen offset:0  lds
    buffer_load_dwordx4 v249, s[12:15], s29 offen offset:1024  lds
    buffer_load_dwordx4 v248, s[12:15], s29 offen offset:2048  lds
    buffer_load_dwordx4 v249, s[12:15], s29 offen offset:3072  lds
L_nd_3:
    v_mfma_f32_16x16x32_bf16 v[44:47], v[184:187], v[136:139], v[44:47]
    v_exp_f32 v109, v109
    v_mfma_f32_16x16x32_bf16 v[48:51], v[184:187], v[144:147], v[48:51]
    ds_read_b128 v[176:179], v235 offset:20480
    ds_read_b64_tr_b16 v[180:181], v236 offset:0
    v_mfma_f32_16x16x32_bf16 v[52:55], v[188:191], v[136:139], v[52:55]
    v_exp_f32 v110, v110
    v_mfma_f32_16x16x32_bf16 v[56:59], v[188:191], v[144:147], v[56:59]
    ds_read_b64_tr_b16 v[182:183], v236 offset:4096
    v_cvt_pk_bf16_f32 v140, v108, v109
    v_mfma_f32_16x16x32_bf16 v[60:63], v[192:195], v[136:139], v[60:63]
    v_exp_f32 v111, v111
    v_mfma_f32_16x16x32_bf16 v[64:67], v[192:195], v[144:147], v[64:67]
    ds_read_b64_tr_b16 v[184:185], v237 offset:0
    ds_read_b64_tr_b16 v[186:187], v237 offset:4096
    v_mfma_f32_16x16x32_bf16 v[68:71], v[196:199], v[136:139], v[68:71]
    v_exp_f32 v112, v112
    v_mfma_f32_16x16x32_bf16 v[72:75], v[196:199], v[144:147], v[72:75]
    ds_read_b64_tr_b16 v[188:189], v238 offset:0
    v_cvt_pk_bf16_f32 v141, v110, v111
    v_mfma_f32_16x16x32_bf16 v[76:79], v[200:203], v[136:139], v[76:79]
    v_exp_f32 v113, v113
    v_mfma_f32_16x16x32_bf16 v[80:83], v[200:203], v[144:147], v[80:83]
    ds_read_b64_tr_b16 v[190:191], v238 offset:4096
    ds_read_b64_tr_b16 v[192:193], v239 offset:0
    v_mfma_f32_16x16x32_bf16 v[84:87], v[204:207], v[136:139], v[84:87]
    v_exp_f32 v114, v114
    v_mfma_f32_16x16x32_bf16 v[88:91], v[204:207], v[144:147], v[88:91]
    ds_read_b64_tr_b16 v[194:195], v239 offset:4096
    v_cvt_pk_bf16_f32 v142, v112, v113
    v_mfma_f32_16x16x32_bf16 v[92:95], v[208:211], v[136:139], v[92:95]
    v_exp_f32 v115, v115
    v_mfma_f32_16x16x32_bf16 v[96:99], v[208:211], v[144:147], v[96:99]
    ds_read_b64_tr_b16 v[196:197], v240 offset:0
    ds_read_b64_tr_b16 v[198:199], v240 offset:4096
    ds_read_b64_tr_b16 v[200:201], v241 offset:0
    s_waitcnt lgkmcnt(11)
    v_mfma_f32_16x16x32_bf16 v[100:103], v[148:151], v[4:7], v[224:227]
    v_exp_f32 v116, v116
    v_mfma_f32_16x16x32_bf16 v[100:103], v[152:155], v[8:11], v[100:103]
    ds_read_b64_tr_b16 v[202:203], v241 offset:4096
    v_cvt_pk_bf16_f32 v143, v114, v115
    v_mfma_f32_16x16x32_bf16 v[100:103], v[156:159], v[12:15], v[100:103]
    v_exp_f32 v117, v117
    v_mfma_f32_16x16x32_bf16 v[100:103], v[160:163], v[16:19], v[100:103]
    ds_read_b64_tr_b16 v[204:205], v242 offset:0
    ds_read_b64_tr_b16 v[206:207], v242 offset:4096
    v_mfma_f32_16x16x32_bf16 v[108:111], v[148:151], v[20:23], v[228:231]
    v_exp_f32 v118, v118
    v_mfma_f32_16x16x32_bf16 v[108:111], v[152:155], v[24:27], v[108:111]
    ds_read_b64_tr_b16 v[208:209], v243 offset:0
    v_cvt_pk_bf16_f32 v136, v116, v117
    v_mfma_f32_16x16x32_bf16 v[108:111], v[156:159], v[28:31], v[108:111]
    v_exp_f32 v119, v119
    v_mfma_f32_16x16x32_bf16 v[108:111], v[160:163], v[32:35], v[108:111]
    ds_read_b64_tr_b16 v[210:211], v243 offset:4096
    ds_read_b128 v[148:151], v232 offset:24576
    v_mfma_f32_16x16x32_bf16 v[104:107], v[164:167], v[4:7], v[224:227]
    v_exp_f32 v120, v120
    v_mfma_f32_16x16x32_bf16 v[104:107], v[168:171], v[8:11], v[104:107]
    ds_read_b128 v[152:155], v233 offset:24576
    v_cvt_pk_bf16_f32 v137, v118, v119
    v_mfma_f32_16x16x32_bf16 v[104:107], v[172:175], v[12:15], v[104:107]
    v_exp_f32 v121, v121
    v_mfma_f32_16x16x32_bf16 v[104:107], v[176:179], v[16:19], v[104:107]
    ds_read_b128 v[156:159], v234 offset:24576
    ds_read_b128 v[160:163], v235 offset:24576
    v_mfma_f32_16x16x32_bf16 v[112:115], v[164:167], v[20:23], v[228:231]
    v_exp_f32 v122, v122
    v_mfma_f32_16x16x32_bf16 v[112:115], v[168:171], v[24:27], v[112:115]
    ds_read_b128 v[164:167], v232 offset:28672
    v_cvt_pk_bf16_f32 v138, v120, v121
    v_mfma_f32_16x16x32_bf16 v[112:115], v[172:175], v[28:31], v[112:115]
    v_exp_f32 v123, v123
    v_mfma_f32_16x16x32_bf16 v[112:115], v[176:179], v[32:35], v[112:115]
    ds_read_b128 v[168:171], v233 offset:28672
    ds_read_b128 v[172:175], v234 offset:28672
    s_waitcnt lgkmcnt(7)
    v_mfma_f32_16x16x32_bf16 v[36:39], v[180:183], v[132:135], v[36:39]
    v_exp_f32 v124, v124
    v_mfma_f32_16x16x32_bf16 v[40:43], v[180:183], v[140:143], v[40:43]
    ds_read_b128 v[176:179], v235 offset:28672
    v_cvt_pk_bf16_f32 v139, v122, v123
    v_mfma_f32_16x16x32_bf16 v[44:47], v[184:187], v[132:135], v[44:47]
    v_exp_f32 v125, v125
    v_mfma_f32_16x16x32_bf16 v[48:51], v[184:187], v[140:143], v[48:51]
    ds_read_b64_tr_b16 v[180:181], v236 offset:8192
    ds_read_b64_tr_b16 v[182:183], v236 offset:12288
    v_mfma_f32_16x16x32_bf16 v[52:55], v[188:191], v[132:135], v[52:55]
    v_exp_f32 v126, v126
    v_mfma_f32_16x16x32_bf16 v[56:59], v[188:191], v[140:143], v[56:59]
    ds_read_b64_tr_b16 v[184:185], v237 offset:8192
    v_cvt_pk_bf16_f32 v144, v124, v125
    v_mfma_f32_16x16x32_bf16 v[60:63], v[192:195], v[132:135], v[60:63]
    v_exp_f32 v127, v127
    v_mfma_f32_16x16x32_bf16 v[64:67], v[192:195], v[140:143], v[64:67]
    ds_read_b64_tr_b16 v[186:187], v237 offset:12288
    ds_read_b64_tr_b16 v[188:189], v238 offset:8192
    v_mfma_f32_16x16x32_bf16 v[68:71], v[196:199], v[132:135], v[68:71]
    v_exp_f32 v128, v128
    v_mfma_f32_16x16x32_bf16 v[72:75], v[196:199], v[140:143], v[72:75]
    ds_read_b64_tr_b16 v[190:191], v238 offset:12288
    v_cvt_pk_bf16_f32 v145, v126, v127
    v_mfma_f32_16x16x32_bf16 v[76:79], v[200:203], v[132:135], v[76:79]
    v_exp_f32 v129, v129
    v_mfma_f32_16x16x32_bf16 v[80:83], v[200:203], v[140:143], v[80:83]
    ds_read_b64_tr_b16 v[192:193], v239 offset:8192
    ds_read_b64_tr_b16 v[194:195], v239 offset:12288
    v_mfma_f32_16x16x32_bf16 v[84:87], v[204:207], v[132:135], v[84:87]
    v_exp_f32 v130, v130
    v_mfma_f32_16x16x32_bf16 v[88:91], v[204:207], v[140:143], v[88:91]
    ds_read_b64_tr_b16 v[196:197], v240 offset:8192
    v_cvt_pk_bf16_f32 v146, v128, v129
    v_mfma_f32_16x16x32_bf16 v[92:95], v[208:211], v[132:135], v[92:95]
    v_exp_f32 v131, v131
    v_mfma_f32_16x16x32_bf16 v[96:99], v[208:211], v[140:143], v[96:99]
    ds_read_b64_tr_b16 v[198:199], v240 offset:12288
    ds_read_b64_tr_b16 v[200:201], v241 offset:8192
    v_smfmac_f32_16x16x64_bf16 v[212:215], v[220:223], v[132:139], v253
    s_waitcnt lgkmcnt(11)
    v_mfma_f32_16x16x32_bf16 v[116:119], v[148:151], v[4:7], v[224:227]
    v_exp_f32 v100, v100
    v_mfma_f32_16x16x32_bf16 v[116:119], v[152:155], v[8:11], v[116:119]
    ds_read_b64_tr_b16 v[202:203], v241 offset:12288
    v_cvt_pk_bf16_f32 v147, v130, v131
    v_mfma_f32_16x16x32_bf16 v[116:119], v[156:159], v[12:15], v[116:119]
    v_exp_f32 v101, v101
    v_mfma_f32_16x16x32_bf16 v[116:119], v[160:163], v[16:19], v[116:119]
    ds_read_b64_tr_b16 v[204:205], v242 offset:8192
    ds_read_b64_tr_b16 v[206:207], v242 offset:12288
    v_mfma_f32_16x16x32_bf16 v[124:127], v[148:151], v[20:23], v[228:231]
    v_exp_f32 v102, v102
    v_mfma_f32_16x16x32_bf16 v[124:127], v[152:155], v[24:27], v[124:127]
    ds_read_b64_tr_b16 v[208:209], v243 offset:8192
    ds_read_b64_tr_b16 v[210:211], v243 offset:12288
    v_mfma_f32_16x16x32_bf16 v[124:127], v[156:159], v[28:31], v[124:127]
    v_exp_f32 v103, v103
    v_mfma_f32_16x16x32_bf16 v[124:127], v[160:163], v[32:35], v[124:127]
    v_cvt_pk_bf16_f32 v132, v100, v101
    v_cvt_pk_bf16_f32 v133, v102, v103
    v_mfma_f32_16x16x32_bf16 v[120:123], v[164:167], v[4:7], v[224:227]
    v_exp_f32 v104, v104
    v_mfma_f32_16x16x32_bf16 v[120:123], v[168:171], v[8:11], v[120:123]
    s_waitcnt vmcnt(0) lgkmcnt(0)
    s_barrier
    ds_read_b128 v[148:151], v232 offset:32768
    v_mfma_f32_16x16x32_bf16 v[120:123], v[172:175], v[12:15], v[120:123]
    v_exp_f32 v105, v105
    v_mfma_f32_16x16x32_bf16 v[120:123], v[176:179], v[16:19], v[120:123]
    ds_read_b128 v[152:155], v233 offset:32768
    ds_read_b128 v[156:159], v234 offset:32768
    v_mfma_f32_16x16x32_bf16 v[128:131], v[164:167], v[20:23], v[228:231]
    v_exp_f32 v106, v106
    v_mfma_f32_16x16x32_bf16 v[128:131], v[168:171], v[24:27], v[128:131]
    ds_read_b128 v[160:163], v235 offset:32768
    v_cvt_pk_bf16_f32 v134, v104, v105
    v_mfma_f32_16x16x32_bf16 v[128:131], v[172:175], v[28:31], v[128:131]
    v_exp_f32 v107, v107
    v_mfma_f32_16x16x32_bf16 v[128:131], v[176:179], v[32:35], v[128:131]
    ds_read_b128 v[164:167], v232 offset:36864
    ds_read_b128 v[168:171], v233 offset:36864
    v_smfmac_f32_16x16x64_bf16 v[216:219], v[220:223], v[140:147], v253
    s_waitcnt lgkmcnt(6)
    v_mfma_f32_16x16x32_bf16 v[36:39], v[180:183], v[136:139], v[36:39]
    v_exp_f32 v108, v108
    v_mfma_f32_16x16x32_bf16 v[40:43], v[180:183], v[144:147], v[40:43]
    ds_read_b128 v[172:175], v234 offset:36864
    v_cvt_pk_bf16_f32 v135, v106, v107
    s_cbranch_vccnz L_nd_4
    s_add_u32 m0, s24, 49152
    s_add_u32 s29, s38, 114688
    buffer_load_dwordx4 v244, s[8:11], s29 offen offset:0  lds
    buffer_load_dwordx4 v245, s[8:11], s29 offen offset:1024  lds
    buffer_load_dwordx4 v246, s[8:11], s29 offen offset:2048  lds
    buffer_load_dwordx4 v247, s[8:11], s29 offen offset:3072  lds
    s_add_u32 m0, s24, 98304
    s_add_u32 s29, s38, 98304
    buffer_load_dwordx4 v248, s[12:15], s29 offen offset:0  lds
    buffer_load_dwordx4 v249, s[12:15], s29 offen offset:1024  lds
    buffer_load_dwordx4 v248, s[12:15], s29 offen offset:2048  lds
    buffer_load_dwordx4 v249, s[12:15], s29 offen offset:3072  lds
L_nd_4:
    v_mfma_f32_16x16x32_bf16 v[44:47], v[184:187], v[136:139], v[44:47]
    v_exp_f32 v109, v109
    v_mfma_f32_16x16x32_bf16 v[48:51], v[184:187], v[144:147], v[48:51]
    ds_read_b128 v[176:179], v235 offset:36864
    ds_read_b64_tr_b16 v[180:181], v236 offset:16384
    v_mfma_f32_16x16x32_bf16 v[52:55], v[188:191], v[136:139], v[52:55]
    v_exp_f32 v110, v110
    v_mfma_f32_16x16x32_bf16 v[56:59], v[188:191], v[144:147], v[56:59]
    ds_read_b64_tr_b16 v[182:183], v236 offset:20480
    v_cvt_pk_bf16_f32 v140, v108, v109
    v_mfma_f32_16x16x32_bf16 v[60:63], v[192:195], v[136:139], v[60:63]
    v_exp_f32 v111, v111
    v_mfma_f32_16x16x32_bf16 v[64:67], v[192:195], v[144:147], v[64:67]
    ds_read_b64_tr_b16 v[184:185], v237 offset:16384
    ds_read_b64_tr_b16 v[186:187], v237 offset:20480
    v_mfma_f32_16x16x32_bf16 v[68:71], v[196:199], v[136:139], v[68:71]
    v_exp_f32 v112, v112
    v_mfma_f32_16x16x32_bf16 v[72:75], v[196:199], v[144:147], v[72:75]
    ds_read_b64_tr_b16 v[188:189], v238 offset:16384
    v_cvt_pk_bf16_f32 v141, v110, v111
    v_mfma_f32_16x16x32_bf16 v[76:79], v[200:203], v[136:139], v[76:79]
    v_exp_f32 v113, v113
    v_mfma_f32_16x16x32_bf16 v[80:83], v[200:203], v[144:147], v[80:83]
    ds_read_b64_tr_b16 v[190:191], v238 offset:20480
    ds_read_b64_tr_b16 v[192:193], v239 offset:16384
    v_mfma_f32_16x16x32_bf16 v[84:87], v[204:207], v[136:139], v[84:87]
    v_exp_f32 v114, v114
    v_mfma_f32_16x16x32_bf16 v[88:91], v[204:207], v[144:147], v[88:91]
    ds_read_b64_tr_b16 v[194:195], v239 offset:20480
    v_cvt_pk_bf16_f32 v142, v112, v113
    v_mfma_f32_16x16x32_bf16 v[92:95], v[208:211], v[136:139], v[92:95]
    v_exp_f32 v115, v115
    v_mfma_f32_16x16x32_bf16 v[96:99], v[208:211], v[144:147], v[96:99]
    ds_read_b64_tr_b16 v[196:197], v240 offset:16384
    ds_read_b64_tr_b16 v[198:199], v240 offset:20480
    ds_read_b64_tr_b16 v[200:201], v241 offset:16384
    s_waitcnt lgkmcnt(11)
    v_mfma_f32_16x16x32_bf16 v[100:103], v[148:151], v[4:7], v[224:227]
    v_exp_f32 v116, v116
    v_mfma_f32_16x16x32_bf16 v[100:103], v[152:155], v[8:11], v[100:103]
    ds_read_b64_tr_b16 v[202:203], v241 offset:20480
    v_cvt_pk_bf16_f32 v143, v114, v115
    v_mfma_f32_16x16x32_bf16 v[100:103], v[156:159], v[12:15], v[100:103]
    v_exp_f32 v117, v117
    v_mfma_f32_16x16x32_bf16 v[100:103], v[160:163], v[16:19], v[100:103]
    ds_read_b64_tr_b16 v[204:205], v242 offset:16384
    ds_read_b64_tr_b16 v[206:207], v242 offset:20480
    v_mfma_f32_16x16x32_bf16 v[108:111], v[148:151], v[20:23], v[228:231]
    v_exp_f32 v118, v118
    v_mfma_f32_16x16x32_bf16 v[108:111], v[152:155], v[24:27], v[108:111]
    ds_read_b64_tr_b16 v[208:209], v243 offset:16384
    v_cvt_pk_bf16_f32 v136, v116, v117
    v_mfma_f32_16x16x32_bf16 v[108:111], v[156:159], v[28:31], v[108:111]
    v_exp_f32 v119, v119
    v_mfma_f32_16x16x32_bf16 v[108:111], v[160:163], v[32:35], v[108:111]
    ds_read_b64_tr_b16 v[210:211], v243 offset:20480
    ds_read_b128 v[148:151], v232 offset:40960
    v_mfma_f32_16x16x32_bf16 v[104:107], v[164:167], v[4:7], v[224:227]
    v_exp_f32 v120, v120
    v_mfma_f32_16x16x32_bf16 v[104:107], v[168:171], v[8:11], v[104:107]
    ds_read_b128 v[152:155], v233 offset:40960
    v_cvt_pk_bf16_f32 v137, v118, v119
    v_mfma_f32_16x16x32_bf16 v[104:107], v[172:175], v[12:15], v[104:107]
    v_exp_f32 v121, v121
    v_mfma_f32_16x16x32_bf16 v[104:107], v[176:179], v[16:19], v[104:107]
    ds_read_b128 v[156:159], v234 offset:40960
    ds_read_b128 v[160:163], v235 offset:40960
    v_mfma_f32_16x16x32_bf16 v[112:115], v[164:167], v[20:23], v[228:231]
    v_exp_f32 v122, v122
    v_mfma_f32_16x16x32_bf16 v[112:115], v[168:171], v[24:27], v[112:115]
    ds_read_b128 v[164:167], v232 offset:45056
    v_cvt_pk_bf16_f32 v138, v120, v121
    v_mfma_f32_16x16x32_bf16 v[112:115], v[172:175], v[28:31], v[112:115]
    v_exp_f32 v123, v123
    v_mfma_f32_16x16x32_bf16 v[112:115], v[176:179], v[32:35], v[112:115]
    ds_read_b128 v[168:171], v233 offset:45056
    ds_read_b128 v[172:175], v234 offset:45056
    s_waitcnt lgkmcnt(7)
    v_mfma_f32_16x16x32_bf16 v[36:39], v[180:183], v[132:135], v[36:39]
    v_exp_f32 v124, v124
    v_mfma_f32_16x16x32_bf16 v[40:43], v[180:183], v[140:143], v[40:43]
    ds_read_b128 v[176:179], v235 offset:45056
    v_cvt_pk_bf16_f32 v139, v122, v123
    v_mfma_f32_16x16x32_bf16 v[44:47], v[184:187], v[132:135], v[44:47]
    v_exp_f32 v125, v125
    v_mfma_f32_16x16x32_bf16 v[48:51], v[184:187], v[140:143], v[48:51]
    ds_read_b64_tr_b16 v[180:181], v236 offset:24576
    ds_read_b64_tr_b16 v[182:183], v236 offset:28672
    v_mfma_f32_16x16x32_bf16 v[52:55], v[188:191], v[132:135], v[52:55]
    v_exp_f32 v126, v126
    v_mfma_f32_16x16x32_bf16 v[56:59], v[188:191], v[140:143], v[56:59]
    ds_read_b64_tr_b16 v[184:185], v237 offset:24576
    v_cvt_pk_bf16_f32 v144, v124, v125
    v_mfma_f32_16x16x32_bf16 v[60:63], v[192:195], v[132:135], v[60:63]
    v_exp_f32 v127, v127
    v_mfma_f32_16x16x32_bf16 v[64:67], v[192:195], v[140:143], v[64:67]
    ds_read_b64_tr_b16 v[186:187], v237 offset:28672
    ds_read_b64_tr_b16 v[188:189], v238 offset:24576
    v_mfma_f32_16x16x32_bf16 v[68:71], v[196:199], v[132:135], v[68:71]
    v_exp_f32 v128, v128
    v_mfma_f32_16x16x32_bf16 v[72:75], v[196:199], v[140:143], v[72:75]
    ds_read_b64_tr_b16 v[190:191], v238 offset:28672
    v_cvt_pk_bf16_f32 v145, v126, v127
    v_mfma_f32_16x16x32_bf16 v[76:79], v[200:203], v[132:135], v[76:79]
    v_exp_f32 v129, v129
    v_mfma_f32_16x16x32_bf16 v[80:83], v[200:203], v[140:143], v[80:83]
    ds_read_b64_tr_b16 v[192:193], v239 offset:24576
    ds_read_b64_tr_b16 v[194:195], v239 offset:28672
    v_mfma_f32_16x16x32_bf16 v[84:87], v[204:207], v[132:135], v[84:87]
    v_exp_f32 v130, v130
    v_mfma_f32_16x16x32_bf16 v[88:91], v[204:207], v[140:143], v[88:91]
    ds_read_b64_tr_b16 v[196:197], v240 offset:24576
    v_cvt_pk_bf16_f32 v146, v128, v129
    v_mfma_f32_16x16x32_bf16 v[92:95], v[208:211], v[132:135], v[92:95]
    v_exp_f32 v131, v131
    v_mfma_f32_16x16x32_bf16 v[96:99], v[208:211], v[140:143], v[96:99]
    ds_read_b64_tr_b16 v[198:199], v240 offset:28672
    ds_read_b64_tr_b16 v[200:201], v241 offset:24576
    v_smfmac_f32_16x16x64_bf16 v[212:215], v[220:223], v[132:139], v253
    s_waitcnt lgkmcnt(11)
    v_mfma_f32_16x16x32_bf16 v[116:119], v[148:151], v[4:7], v[224:227]
    v_exp_f32 v100, v100
    v_mfma_f32_16x16x32_bf16 v[116:119], v[152:155], v[8:11], v[116:119]
    ds_read_b64_tr_b16 v[202:203], v241 offset:28672
    v_cvt_pk_bf16_f32 v147, v130, v131
    v_mfma_f32_16x16x32_bf16 v[116:119], v[156:159], v[12:15], v[116:119]
    v_exp_f32 v101, v101
    v_mfma_f32_16x16x32_bf16 v[116:119], v[160:163], v[16:19], v[116:119]
    ds_read_b64_tr_b16 v[204:205], v242 offset:24576
    ds_read_b64_tr_b16 v[206:207], v242 offset:28672
    v_mfma_f32_16x16x32_bf16 v[124:127], v[148:151], v[20:23], v[228:231]
    v_exp_f32 v102, v102
    v_mfma_f32_16x16x32_bf16 v[124:127], v[152:155], v[24:27], v[124:127]
    ds_read_b64_tr_b16 v[208:209], v243 offset:24576
    ds_read_b64_tr_b16 v[210:211], v243 offset:28672
    v_mfma_f32_16x16x32_bf16 v[124:127], v[156:159], v[28:31], v[124:127]
    v_exp_f32 v103, v103
    v_mfma_f32_16x16x32_bf16 v[124:127], v[160:163], v[32:35], v[124:127]
    v_cvt_pk_bf16_f32 v132, v100, v101
    v_cvt_pk_bf16_f32 v133, v102, v103
    v_mfma_f32_16x16x32_bf16 v[120:123], v[164:167], v[4:7], v[224:227]
    v_exp_f32 v104, v104
    v_mfma_f32_16x16x32_bf16 v[120:123], v[168:171], v[8:11], v[120:123]
    s_cbranch_vccnz L_nd_5
    s_waitcnt vmcnt(0) lgkmcnt(0)
    s_barrier
L_nd_5:
    ds_read_b128 v[148:151], v232 offset:49152
    v_mfma_f32_16x16x32_bf16 v[120:123], v[172:175], v[12:15], v[120:123]
    v_exp_f32 v105, v105
    v_mfma_f32_16x16x32_bf16 v[120:123], v[176:179], v[16:19], v[120:123]
    ds_read_b128 v[152:155], v233 offset:49152
    ds_read_b128 v[156:159], v234 offset:49152
    v_mfma_f32_16x16x32_bf16 v[128:131], v[164:167], v[20:23], v[228:231]
    v_exp_f32 v106, v106
    v_mfma_f32_16x16x32_bf16 v[128:131], v[168:171], v[24:27], v[128:131]
    ds_read_b128 v[160:163], v235 offset:49152
    v_cvt_pk_bf16_f32 v134, v104, v105
    v_mfma_f32_16x16x32_bf16 v[128:131], v[172:175], v[28:31], v[128:131]
    v_exp_f32 v107, v107
    v_mfma_f32_16x16x32_bf16 v[128:131], v[176:179], v[32:35], v[128:131]
    ds_read_b128 v[164:167], v232 offset:53248
    ds_read_b128 v[168:171], v233 offset:53248
    v_smfmac_f32_16x16x64_bf16 v[216:219], v[220:223], v[140:147], v253
    s_waitcnt lgkmcnt(6)
    v_mfma_f32_16x16x32_bf16 v[36:39], v[180:183], v[136:139], v[36:39]
    v_exp_f32 v108, v108
    v_mfma_f32_16x16x32_bf16 v[40:43], v[180:183], v[144:147], v[40:43]
    ds_read_b128 v[172:175], v234 offset:53248
    v_cvt_pk_bf16_f32 v135, v106, v107
    s_cbranch_vccnz L_nd_6
    s_add_u32 m0, s24, 114688
    s_add_u32 s29, s38, 114688
    buffer_load_dwordx4 v248, s[12:15], s29 offen offset:0  lds
    buffer_load_dwordx4 v249, s[12:15], s29 offen offset:1024  lds
    buffer_load_dwordx4 v248, s[12:15], s29 offen offset:2048  lds
    buffer_load_dwordx4 v249, s[12:15], s29 offen offset:3072  lds
L_nd_6:
    v_mfma_f32_16x16x32_bf16 v[44:47], v[184:187], v[136:139], v[44:47]
    v_exp_f32 v109, v109
    v_mfma_f32_16x16x32_bf16 v[48:51], v[184:187], v[144:147], v[48:51]
    ds_read_b128 v[176:179], v235 offset:53248
    ds_read_b64_tr_b16 v[180:181], v236 offset:32768
    v_mfma_f32_16x16x32_bf16 v[52:55], v[188:191], v[136:139], v[52:55]
    v_exp_f32 v110, v110
    v_mfma_f32_16x16x32_bf16 v[56:59], v[188:191], v[144:147], v[56:59]
    ds_read_b64_tr_b16 v[182:183], v236 offset:36864
    v_cvt_pk_bf16_f32 v140, v108, v109
    v_mfma_f32_16x16x32_bf16 v[60:63], v[192:195], v[136:139], v[60:63]
    v_exp_f32 v111, v111
    v_mfma_f32_16x16x32_bf16 v[64:67], v[192:195], v[144:147], v[64:67]
    ds_read_b64_tr_b16 v[184:185], v237 offset:32768
    ds_read_b64_tr_b16 v[186:187], v237 offset:36864
    v_mfma_f32_16x16x32_bf16 v[68:71], v[196:199], v[136:139], v[68:71]
    v_exp_f32 v112, v112
    v_mfma_f32_16x16x32_bf16 v[72:75], v[196:199], v[144:147], v[72:75]
    ds_read_b64_tr_b16 v[188:189], v238 offset:32768
    v_cvt_pk_bf16_f32 v141, v110, v111
    v_mfma_f32_16x16x32_bf16 v[76:79], v[200:203], v[136:139], v[76:79]
    v_exp_f32 v113, v113
    v_mfma_f32_16x16x32_bf16 v[80:83], v[200:203], v[144:147], v[80:83]
    ds_read_b64_tr_b16 v[190:191], v238 offset:36864
    ds_read_b64_tr_b16 v[192:193], v239 offset:32768
    v_mfma_f32_16x16x32_bf16 v[84:87], v[204:207], v[136:139], v[84:87]
    v_exp_f32 v114, v114
    v_mfma_f32_16x16x32_bf16 v[88:91], v[204:207], v[144:147], v[88:91]
    ds_read_b64_tr_b16 v[194:195], v239 offset:36864
    v_cvt_pk_bf16_f32 v142, v112, v113
    v_mfma_f32_16x16x32_bf16 v[92:95], v[208:211], v[136:139], v[92:95]
    v_exp_f32 v115, v115
    v_mfma_f32_16x16x32_bf16 v[96:99], v[208:211], v[144:147], v[96:99]
    ds_read_b64_tr_b16 v[196:197], v240 offset:32768
    ds_read_b64_tr_b16 v[198:199], v240 offset:36864
    ds_read_b64_tr_b16 v[200:201], v241 offset:32768
    s_waitcnt lgkmcnt(11)
    v_mfma_f32_16x16x32_bf16 v[100:103], v[148:151], v[4:7], v[224:227]
    v_exp_f32 v116, v116
    v_mfma_f32_16x16x32_bf16 v[100:103], v[152:155], v[8:11], v[100:103]
    ds_read_b64_tr_b16 v[202:203], v241 offset:36864
    v_cvt_pk_bf16_f32 v143, v114, v115
    v_mfma_f32_16x16x32_bf16 v[100:103], v[156:159], v[12:15], v[100:103]
    v_exp_f32 v117, v117
    v_mfma_f32_16x16x32_bf16 v[100:103], v[160:163], v[16:19], v[100:103]
    ds_read_b64_tr_b16 v[204:205], v242 offset:32768
    ds_read_b64_tr_b16 v[206:207], v242 offset:36864
    v_mfma_f32_16x16x32_bf16 v[108:111], v[148:151], v[20:23], v[228:231]
    v_exp_f32 v118, v118
    v_mfma_f32_16x16x32_bf16 v[108:111], v[152:155], v[24:27], v[108:111]
    ds_read_b64_tr_b16 v[208:209], v243 offset:32768
    v_cvt_pk_bf16_f32 v136, v116, v117
    v_mfma_f32_16x16x32_bf16 v[108:111], v[156:159], v[28:31], v[108:111]
    v_exp_f32 v119, v119
    v_mfma_f32_16x16x32_bf16 v[108:111], v[160:163], v[32:35], v[108:111]
    ds_read_b64_tr_b16 v[210:211], v243 offset:36864
    ds_read_b128 v[148:151], v232 offset:57344
    v_mfma_f32_16x16x32_bf16 v[104:107], v[164:167], v[4:7], v[224:227]
    v_exp_f32 v120, v120
    v_mfma_f32_16x16x32_bf16 v[104:107], v[168:171], v[8:11], v[104:107]
    ds_read_b128 v[152:155], v233 offset:57344
    v_cvt_pk_bf16_f32 v137, v118, v119
    v_mfma_f32_16x16x32_bf16 v[104:107], v[172:175], v[12:15], v[104:107]
    v_exp_f32 v121, v121
    v_mfma_f32_16x16x32_bf16 v[104:107], v[176:179], v[16:19], v[104:107]
    ds_read_b128 v[156:159], v234 offset:57344
    ds_read_b128 v[160:163], v235 offset:57344
    v_mfma_f32_16x16x32_bf16 v[112:115], v[164:167], v[20:23], v[228:231]
    v_exp_f32 v122, v122
    v_mfma_f32_16x16x32_bf16 v[112:115], v[168:171], v[24:27], v[112:115]
    ds_read_b128 v[164:167], v232 offset:61440
    v_cvt_pk_bf16_f32 v138, v120, v121
    v_mfma_f32_16x16x32_bf16 v[112:115], v[172:175], v[28:31], v[112:115]
    v_exp_f32 v123, v123
    v_mfma_f32_16x16x32_bf16 v[112:115], v[176:179], v[32:35], v[112:115]
    ds_read_b128 v[168:171], v233 offset:61440
    ds_read_b128 v[172:175], v234 offset:61440
    s_waitcnt lgkmcnt(7)
    v_mfma_f32_16x16x32_bf16 v[36:39], v[180:183], v[132:135], v[36:39]
    v_exp_f32 v124, v124
    v_mfma_f32_16x16x32_bf16 v[40:43], v[180:183], v[140:143], v[40:43]
    ds_read_b128 v[176:179], v235 offset:61440
    v_cvt_pk_bf16_f32 v139, v122, v123
    v_mfma_f32_16x16x32_bf16 v[44:47], v[184:187], v[132:135], v[44:47]
    v_exp_f32 v125, v125
    v_mfma_f32_16x16x32_bf16 v[48:51], v[184:187], v[140:143], v[48:51]
    ds_read_b64_tr_b16 v[180:181], v236 offset:40960
    ds_read_b64_tr_b16 v[182:183], v236 offset:45056
    v_mfma_f32_16x16x32_bf16 v[52:55], v[188:191], v[132:135], v[52:55]
    v_exp_f32 v126, v126
    v_mfma_f32_16x16x32_bf16 v[56:59], v[188:191], v[140:143], v[56:59]
    ds_read_b64_tr_b16 v[184:185], v237 offset:40960
    v_cvt_pk_bf16_f32 v144, v124, v125
    v_mfma_f32_16x16x32_bf16 v[60:63], v[192:195], v[132:135], v[60:63]
    v_exp_f32 v127, v127
    v_mfma_f32_16x16x32_bf16 v[64:67], v[192:195], v[140:143], v[64:67]
    ds_read_b64_tr_b16 v[186:187], v237 offset:45056
    ds_read_b64_tr_b16 v[188:189], v238 offset:40960
    v_mfma_f32_16x16x32_bf16 v[68:71], v[196:199], v[132:135], v[68:71]
    v_exp_f32 v128, v128
    v_mfma_f32_16x16x32_bf16 v[72:75], v[196:199], v[140:143], v[72:75]
    ds_read_b64_tr_b16 v[190:191], v238 offset:45056
    v_cvt_pk_bf16_f32 v145, v126, v127
    v_mfma_f32_16x16x32_bf16 v[76:79], v[200:203], v[132:135], v[76:79]
    v_exp_f32 v129, v129
    v_mfma_f32_16x16x32_bf16 v[80:83], v[200:203], v[140:143], v[80:83]
    ds_read_b64_tr_b16 v[192:193], v239 offset:40960
    ds_read_b64_tr_b16 v[194:195], v239 offset:45056
    v_mfma_f32_16x16x32_bf16 v[84:87], v[204:207], v[132:135], v[84:87]
    v_exp_f32 v130, v130
    v_mfma_f32_16x16x32_bf16 v[88:91], v[204:207], v[140:143], v[88:91]
    ds_read_b64_tr_b16 v[196:197], v240 offset:40960
    v_cvt_pk_bf16_f32 v146, v128, v129
    v_mfma_f32_16x16x32_bf16 v[92:95], v[208:211], v[132:135], v[92:95]
    v_exp_f32 v131, v131
    v_mfma_f32_16x16x32_bf16 v[96:99], v[208:211], v[140:143], v[96:99]
    ds_read_b64_tr_b16 v[198:199], v240 offset:45056
    ds_read_b64_tr_b16 v[200:201], v241 offset:40960
    v_smfmac_f32_16x16x64_bf16 v[212:215], v[220:223], v[132:139], v253
    s_waitcnt lgkmcnt(11)
    v_mfma_f32_16x16x32_bf16 v[116:119], v[148:151], v[4:7], v[224:227]
    v_exp_f32 v100, v100
    v_mfma_f32_16x16x32_bf16 v[116:119], v[152:155], v[8:11], v[116:119]
    ds_read_b64_tr_b16 v[202:203], v241 offset:45056
    v_cvt_pk_bf16_f32 v147, v130, v131
    v_mfma_f32_16x16x32_bf16 v[116:119], v[156:159], v[12:15], v[116:119]
    v_exp_f32 v101, v101
    v_mfma_f32_16x16x32_bf16 v[116:119], v[160:163], v[16:19], v[116:119]
    ds_read_b64_tr_b16 v[204:205], v242 offset:40960
    ds_read_b64_tr_b16 v[206:207], v242 offset:45056
    v_mfma_f32_16x16x32_bf16 v[124:127], v[148:151], v[20:23], v[228:231]
    v_exp_f32 v102, v102
    v_mfma_f32_16x16x32_bf16 v[124:127], v[152:155], v[24:27], v[124:127]
    ds_read_b64_tr_b16 v[208:209], v243 offset:40960
    ds_read_b64_tr_b16 v[210:211], v243 offset:45056
    v_mfma_f32_16x16x32_bf16 v[124:127], v[156:159], v[28:31], v[124:127]
    v_exp_f32 v103, v103
    v_mfma_f32_16x16x32_bf16 v[124:127], v[160:163], v[32:35], v[124:127]
    v_cvt_pk_bf16_f32 v132, v100, v101
    v_cvt_pk_bf16_f32 v133, v102, v103
    v_mfma_f32_16x16x32_bf16 v[120:123], v[164:167], v[4:7], v[224:227]
    v_exp_f32 v104, v104
    v_mfma_f32_16x16x32_bf16 v[120:123], v[168:171], v[8:11], v[120:123]
    s_cbranch_vccnz L_nd_7
    s_waitcnt vmcnt(0) lgkmcnt(0)
    s_barrier
L_nd_7:
    ds_read_b64_tr_b16 v[148:149], v236 offset:57344
    v_mfma_f32_16x16x32_bf16 v[120:123], v[172:175], v[12:15], v[120:123]
    v_exp_f32 v105, v105
    v_mfma_f32_16x16x32_bf16 v[120:123], v[176:179], v[16:19], v[120:123]
    ds_read_b64_tr_b16 v[150:151], v236 offset:61440
    ds_read_b64_tr_b16 v[152:153], v237 offset:57344
    v_mfma_f32_16x16x32_bf16 v[128:131], v[164:167], v[20:23], v[228:231]
    v_exp_f32 v106, v106
    v_mfma_f32_16x16x32_bf16 v[128:131], v[168:171], v[24:27], v[128:131]
    ds_read_b64_tr_b16 v[154:155], v237 offset:61440
    v_cvt_pk_bf16_f32 v134, v104, v105
    v_mfma_f32_16x16x32_bf16 v[128:131], v[172:175], v[28:31], v[128:131]
    v_exp_f32 v107, v107
    v_mfma_f32_16x16x32_bf16 v[128:131], v[176:179], v[32:35], v[128:131]
    ds_read_b64_tr_b16 v[156:157], v238 offset:57344
    ds_read_b64_tr_b16 v[158:159], v238 offset:61440
    v_smfmac_f32_16x16x64_bf16 v[216:219], v[220:223], v[140:147], v253
    s_waitcnt lgkmcnt(6)
    v_mfma_f32_16x16x32_bf16 v[36:39], v[180:183], v[136:139], v[36:39]
    v_exp_f32 v108, v108
    v_mfma_f32_16x16x32_bf16 v[40:43], v[180:183], v[144:147], v[40:43]
    ds_read_b64_tr_b16 v[160:161], v239 offset:57344
    v_cvt_pk_bf16_f32 v135, v106, v107
    v_mfma_f32_16x16x32_bf16 v[44:47], v[184:187], v[136:139], v[44:47]
    v_exp_f32 v109, v109
    v_mfma_f32_16x16x32_bf16 v[48:51], v[184:187], v[144:147], v[48:51]
    ds_read_b64_tr_b16 v[162:163], v239 offset:61440
    ds_read_b64_tr_b16 v[180:181], v236 offset:49152
    v_mfma_f32_16x16x32_bf16 v[52:55], v[188:191], v[136:139], v[52:55]
    v_exp_f32 v110, v110
    v_mfma_f32_16x16x32_bf16 v[56:59], v[188:191], v[144:147], v[56:59]
    ds_read_b64_tr_b16 v[182:183], v236 offset:53248
    v_cvt_pk_bf16_f32 v140, v108, v109
    v_mfma_f32_16x16x32_bf16 v[60:63], v[192:195], v[136:139], v[60:63]
    v_exp_f32 v111, v111
    v_mfma_f32_16x16x32_bf16 v[64:67], v[192:195], v[144:147], v[64:67]
    ds_read_b64_tr_b16 v[184:185], v237 offset:49152
    ds_read_b64_tr_b16 v[186:187], v237 offset:53248
    v_mfma_f32_16x16x32_bf16 v[68:71], v[196:199], v[136:139], v[68:71]
    v_exp_f32 v112, v112
    v_mfma_f32_16x16x32_bf16 v[72:75], v[196:199], v[144:147], v[72:75]
    ds_read_b64_tr_b16 v[188:189], v238 offset:49152
    v_cvt_pk_bf16_f32 v141, v110, v111
    v_mfma_f32_16x16x32_bf16 v[76:79], v[200:203], v[136:139], v[76:79]
    v_exp_f32 v113, v113
    v_mfma_f32_16x16x32_bf16 v[80:83], v[200:203], v[144:147], v[80:83]
    ds_read_b64_tr_b16 v[190:191], v238 offset:53248
    ds_read_b64_tr_b16 v[192:193], v239 offset:49152
    v_mfma_f32_16x16x32_bf16 v[84:87], v[204:207], v[136:139], v[84:87]
    v_exp_f32 v114, v114
    v_mfma_f32_16x16x32_bf16 v[88:91], v[204:207], v[144:147], v[88:91]
    ds_read_b64_tr_b16 v[194:195], v239 offset:53248
    v_cvt_pk_bf16_f32 v142, v112, v113
    v_mfma_f32_16x16x32_bf16 v[92:95], v[208:211], v[136:139], v[92:95]
    v_exp_f32 v115, v115
    v_mfma_f32_16x16x32_bf16 v[96:99], v[208:211], v[144:147], v[96:99]
    ds_read_b64_tr_b16 v[196:197], v240 offset:49152
    ds_read_b64_tr_b16 v[198:199], v240 offset:53248
    ds_read_b64_tr_b16 v[200:201], v241 offset:49152
    s_waitcnt lgkmcnt(7)
    v_mfma_f32_16x16x32_bf16 v[36:39], v[180:183], v[132:135], v[36:39]
    v_cvt_pk_bf16_f32 v143, v114, v115
    v_exp_f32 v116, v116
    v_mov_b32 v232, v250
    v_mfma_f32_16x16x32_bf16 v[40:43], v[180:183], v[140:143], v[40:43]
    v_exp_f32 v117, v117
    ds_read_b64_tr_b16 v[202:203], v241 offset:53248
    ds_read_b64_tr_b16 v[204:205], v242 offset:49152
    v_mfma_f32_16x16x32_bf16 v[44:47], v[184:187], v[132:135], v[44:47]
    v_exp_f32 v118, v118
    v_mfma_f32_16x16x32_bf16 v[48:51], v[184:187], v[140:143], v[48:51]
    v_exp_f32 v119, v119
    ds_read_b64_tr_b16 v[206:207], v242 offset:53248
    ds_read_b64_tr_b16 v[208:209], v243 offset:49152
    v_cvt_pk_bf16_f32 v136, v116, v117
    v_xor_b32 v233, 32, v250
    s_waitcnt lgkmcnt(5)
    v_mfma_f32_16x16x32_bf16 v[52:55], v[188:191], v[132:135], v[52:55]
    v_exp_f32 v120, v120
    v_mfma_f32_16x16x32_bf16 v[56:59], v[188:191], v[140:143], v[56:59]
    v_exp_f32 v121, v121
    ds_read_b64_tr_b16 v[210:211], v243 offset:53248
    ds_read_b64_tr_b16 v[164:165], v240 offset:57344
    v_cvt_pk_bf16_f32 v137, v118, v119
    v_xor_b32 v234, 64, v250
    v_mfma_f32_16x16x32_bf16 v[60:63], v[192:195], v[132:135], v[60:63]
    v_exp_f32 v122, v122
    v_mfma_f32_16x16x32_bf16 v[64:67], v[192:195], v[140:143], v[64:67]
    v_exp_f32 v123, v123
    ds_read_b64_tr_b16 v[166:167], v240 offset:61440
    ds_read_b64_tr_b16 v[168:169], v241 offset:57344
    v_cvt_pk_bf16_f32 v138, v120, v121
    v_xor_b32 v235, 96, v250
    v_mfma_f32_16x16x32_bf16 v[68:71], v[196:199], v[132:135], v[68:71]
    v_exp_f32 v124, v124
    v_mfma_f32_16x16x32_bf16 v[72:75], v[196:199], v[140:143], v[72:75]
    v_exp_f32 v125, v125
    ds_read_b64_tr_b16 v[170:171], v241 offset:61440
    ds_read_b64_tr_b16 v[172:173], v242 offset:57344
    v_cvt_pk_bf16_f32 v139, v122, v123
    s_add_u32 s31, s26, 4096
    s_waitcnt lgkmcnt(5)
    v_mfma_f32_16x16x32_bf16 v[76:79], v[200:203], v[132:135], v[76:79]
    v_exp_f32 v126, v126
    v_mfma_f32_16x16x32_bf16 v[80:83], v[200:203], v[140:143], v[80:83]
    v_exp_f32 v127, v127
    ds_read_b64_tr_b16 v[174:175], v242 offset:61440
    ds_read_b64_tr_b16 v[176:177], v243 offset:57344
    v_cvt_pk_bf16_f32 v144, v124, v125
    s_mov_b32 s29, 0x53800000
    v_mfma_f32_16x16x32_bf16 v[84:87], v[204:207], v[132:135], v[84:87]
    v_exp_f32 v128, v128
    v_mfma_f32_16x16x32_bf16 v[88:91], v[204:207], v[140:143], v[88:91]
    v_exp_f32 v129, v129
    ds_read_b64_tr_b16 v[178:179], v243 offset:61440
    v_cvt_pk_bf16_f32 v145, v126, v127
    v_smfmac_f32_16x16x64_bf16 v[212:215], v[220:223], v[132:139], v253
    v_mfma_f32_16x16x32_bf16 v[92:95], v[208:211], v[132:135], v[92:95]
    v_exp_f32 v130, v130
    v_mfma_f32_16x16x32_bf16 v[96:99], v[208:211], v[140:143], v[96:99]
    v_exp_f32 v131, v131
    v_cvt_pk_bf16_f32 v146, v128, v129
    v_cvt_pk_bf16_f32 v147, v130, v131
    s_nop 0
    v_mfma_f32_16x16x32_bf16 v[36:39], v[148:151], v[136:139], v[36:39]
    v_add_f32 v212, v212, v213
    v_smfmac_f32_16x16x64_bf16 v[216:219], v[220:223], v[140:147], v253
    v_mfma_f32_16x16x32_bf16 v[44:47], v[152:155], v[136:139], v[44:47]
    v_rcp_f32 v2, v212
    v_mfma_f32_16x16x32_bf16 v[52:55], v[156:159], v[136:139], v[52:55]
    v_cmp_nge_f32 vcc, s29, v212
    v_mfma_f32_16x16x32_bf16 v[60:63], v[160:163], v[136:139], v[60:63]
    s_waitcnt lgkmcnt(0)
    v_mfma_f32_16x16x32_bf16 v[68:71], v[164:167], v[136:139], v[68:71]
    v_mfma_f32_16x16x32_bf16 v[76:79], v[168:171], v[136:139], v[76:79]
    v_mul_f32 v36, v2, v36
    v_mul_f32 v37, v2, v37
    v_mfma_f32_16x16x32_bf16 v[84:87], v[172:175], v[136:139], v[84:87]
    v_mul_f32 v38, v2, v38
    v_mul_f32 v39, v2, v39
    v_mfma_f32_16x16x32_bf16 v[92:95], v[176:179], v[136:139], v[92:95]
    v_cvt_pk_bf16_f32 v180, v36, v37
    v_cvt_pk_bf16_f32 v181, v38, v39
    v_add_f32 v216, v216, v217
    v_mfma_f32_16x16x32_bf16 v[40:43], v[148:151], v[144:147], v[40:43]
    ds_write_b64 v232, v[180:181] offset:0
    v_rcp_f32 v3, v216
    v_mul_f32 v44, v2, v44
    v_mul_f32 v45, v2, v45
    v_mul_f32 v46, v2, v46
    v_mfma_f32_16x16x32_bf16 v[48:51], v[152:155], v[144:147], v[48:51]
    v_mul_f32 v47, v2, v47
    v_cvt_pk_bf16_f32 v184, v44, v45
    v_cvt_pk_bf16_f32 v185, v46, v47
    ds_write_b64 v233, v[184:185] offset:0
    v_cmp_nge_f32 s[42:43], s29, v216
    v_mfma_f32_16x16x32_bf16 v[56:59], v[156:159], v[144:147], v[56:59]
    v_mul_f32 v52, v2, v52
    v_mul_f32 v53, v2, v53
    v_mul_f32 v54, v2, v54
    v_mul_f32 v55, v2, v55
    v_cvt_pk_bf16_f32 v188, v52, v53
    v_mfma_f32_16x16x32_bf16 v[64:67], v[160:163], v[144:147], v[64:67]
    v_cvt_pk_bf16_f32 v189, v54, v55
    ds_write_b64 v234, v[188:189] offset:0
    v_mul_f32 v60, v2, v60
    v_mul_f32 v61, v2, v61
    v_mul_f32 v62, v2, v62
    v_mfma_f32_16x16x32_bf16 v[72:75], v[164:167], v[144:147], v[72:75]
    v_mul_f32 v63, v2, v63
    v_cvt_pk_bf16_f32 v192, v60, v61
    v_cvt_pk_bf16_f32 v193, v62, v63
    ds_write_b64 v235, v[192:193] offset:0
    ds_read_b128 v[100:103], v251 offset:0
    v_mfma_f32_16x16x32_bf16 v[80:83], v[168:171], v[144:147], v[80:83]
    ds_read_b128 v[104:107], v251 offset:1024
    v_mul_f32 v68, v2, v68
    v_mul_f32 v69, v2, v69
    v_mul_f32 v70, v2, v70
    v_mul_f32 v71, v2, v71
    v_mfma_f32_16x16x32_bf16 v[88:91], v[172:175], v[144:147], v[88:91]
    v_cvt_pk_bf16_f32 v196, v68, v69
    v_cvt_pk_bf16_f32 v197, v70, v71
    ds_write_b64 v232, v[196:197] offset:0
    v_mul_f32 v76, v2, v76
    v_mul_f32 v77, v2, v77
    v_mfma_f32_16x16x32_bf16 v[96:99], v[176:179], v[144:147], v[96:99]
    v_mul_f32 v78, v2, v78
    v_mul_f32 v79, v2, v79
    v_cvt_pk_bf16_f32 v200, v76, v77
    v_cvt_pk_bf16_f32 v201, v78, v79
    ds_write_b64 v233, v[200:201] offset:0
    s_or_b64 vcc, vcc, s[42:43]
    s_cselect_b32 s41, 1, 0
    s_waitcnt lgkmcnt(2)
    buffer_store_dwordx4 v[100:103], v252, s[20:23], s26 offen offset:0 sc0 sc1 nt
    v_mul_f32 v84, v2, v84
    v_mul_f32 v85, v2, v85
    v_mul_f32 v86, v2, v86
    v_mul_f32 v87, v2, v87
    v_cvt_pk_bf16_f32 v204, v84, v85
    v_cvt_pk_bf16_f32 v205, v86, v87
    ds_write_b64 v234, v[204:205] offset:0
    buffer_store_dwordx4 v[104:107], v252, s[20:23], s26 offen offset:2048 sc0 sc1 nt
    v_mul_f32 v92, v2, v92
    v_mul_f32 v93, v2, v93
    v_mul_f32 v94, v2, v94
    v_mul_f32 v95, v2, v95
    v_cvt_pk_bf16_f32 v208, v92, v93
    v_cvt_pk_bf16_f32 v209, v94, v95
    ds_write_b64 v235, v[208:209] offset:0
    ds_read_b128 v[116:119], v251 offset:0
    ds_read_b128 v[120:123], v251 offset:1024
    v_mul_f32 v40, v3, v40
    v_mul_f32 v41, v3, v41
    v_mul_f32 v42, v3, v42
    v_mul_f32 v43, v3, v43
    v_cvt_pk_bf16_f32 v182, v40, v41
    v_cvt_pk_bf16_f32 v183, v42, v43
    ds_write_b64 v232, v[182:183] offset:2048
    v_mul_f32 v48, v3, v48
    v_mul_f32 v49, v3, v49
    v_mul_f32 v50, v3, v50
    v_mul_f32 v51, v3, v51
    v_cvt_pk_bf16_f32 v186, v48, v49
    v_cvt_pk_bf16_f32 v187, v50, v51
    ds_write_b64 v233, v[186:187] offset:2048
    s_waitcnt lgkmcnt(2)
    buffer_store_dwordx4 v[116:119], v252, s[20:23], s26 offen offset:128 sc0 sc1 nt
    v_mul_f32 v56, v3, v56
    v_mul_f32 v57, v3, v57
    v_mul_f32 v58, v3, v58
    v_mul_f32 v59, v3, v59
    v_cvt_pk_bf16_f32 v190, v56, v57
    v_cvt_pk_bf16_f32 v191, v58, v59
    ds_write_b64 v234, v[190:191] offset:2048
    buffer_store_dwordx4 v[120:123], v252, s[20:23], s26 offen offset:2176 sc0 sc1 nt
    v_mul_f32 v64, v3, v64
    v_mul_f32 v65, v3, v65
    v_mul_f32 v66, v3, v66
    v_mul_f32 v67, v3, v67
    v_cvt_pk_bf16_f32 v194, v64, v65
    v_cvt_pk_bf16_f32 v195, v66, v67
    ds_write_b64 v235, v[194:195] offset:2048
    ds_read_b128 v[108:111], v251 offset:2048
    ds_read_b128 v[112:115], v251 offset:3072
    v_mul_f32 v72, v3, v72
    v_mul_f32 v73, v3, v73
    v_mul_f32 v74, v3, v74
    v_mul_f32 v75, v3, v75
    v_cvt_pk_bf16_f32 v198, v72, v73
    v_cvt_pk_bf16_f32 v199, v74, v75
    ds_write_b64 v232, v[198:199] offset:2048
    v_mul_f32 v80, v3, v80
    v_mul_f32 v81, v3, v81
    v_mul_f32 v82, v3, v82
    v_mul_f32 v83, v3, v83
    v_cvt_pk_bf16_f32 v202, v80, v81
    v_cvt_pk_bf16_f32 v203, v82, v83
    ds_write_b64 v233, v[202:203] offset:2048
    s_waitcnt lgkmcnt(2)
    buffer_store_dwordx4 v[108:111], v252, s[20:23], s31 offen offset:0 sc0 sc1 nt
    v_mul_f32 v88, v3, v88
    v_mul_f32 v89, v3, v89
    v_mul_f32 v90, v3, v90
    v_mul_f32 v91, v3, v91
    v_cvt_pk_bf16_f32 v206, v88, v89
    v_cvt_pk_bf16_f32 v207, v90, v91
    ds_write_b64 v234, v[206:207] offset:2048
    buffer_store_dwordx4 v[112:115], v252, s[20:23], s31 offen offset:2048 sc0 sc1 nt
    v_mul_f32 v96, v3, v96
    v_mul_f32 v97, v3, v97
    v_mul_f32 v98, v3, v98
    v_mul_f32 v99, v3, v99
    v_cvt_pk_bf16_f32 v210, v96, v97
    v_cvt_pk_bf16_f32 v211, v98, v99
    ds_write_b64 v235, v[210:211] offset:2048
    ds_read_b128 v[124:127], v251 offset:2048
    ds_read_b128 v[128:131], v251 offset:3072
    s_waitcnt lgkmcnt(1)
    buffer_store_dwordx4 v[124:127], v252, s[20:23], s31 offen offset:128 sc0 sc1 nt
    s_waitcnt lgkmcnt(0)
    buffer_store_dwordx4 v[128:131], v252, s[20:23], s31 offen offset:2176 sc0 sc1 nt
    s_lshl_b32 s31, s30, 2
    s_add_u32 s31, s31, 0
    v_mov_b32 v1, s31
    v_mov_b32 v2, s41
    ds_write_b32 v1, v2
    s_waitcnt lgkmcnt(0)
    s_barrier
    v_and_b32 v1, 7, v0
    v_lshlrev_b32 v1, 2, v1
    v_add_u32 v1, 0, v1
    ds_read_b32 v2, v1
    s_waitcnt lgkmcnt(0)
    v_cmp_ne_u32 vcc, 0, v2
    s_cmp_lg_u32 s28, 0
    s_cbranch_scc1 L_fin
    s_cbranch_vccnz L_redo
L_fin:
L_end:
    s_endpgm
L_redo:
    s_barrier
    s_mov_b32 s28, 1
    v_and_b32 v1, 15, v0
    v_lshrrev_b32 v2, 4, v0
    v_lshlrev_b32 v1, 8, v1
    v_lshl_add_u32 v1, v2, 4, v1
    v_add_u32 v3, 4096, v1
    v_mov_b32 v224, 0xff800000
    v_mov_b32 v228, 0xff800000
    s_mov_b32 s31, s25
    s_add_u32 s43, s25, 131072
L_redo_loop:
    s_waitcnt vmcnt(0)
    buffer_load_dwordx4 v[148:151], v1, s[8:11], s31 offen offset:0
    buffer_load_dwordx4 v[152:155], v1, s[8:11], s31 offen offset:64
    buffer_load_dwordx4 v[156:159], v1, s[8:11], s31 offen offset:128
    buffer_load_dwordx4 v[160:163], v1, s[8:11], s31 offen offset:192
    buffer_load_dwordx4 v[164:167], v3, s[8:11], s31 offen offset:0
    buffer_load_dwordx4 v[168:171], v3, s[8:11], s31 offen offset:64
    buffer_load_dwordx4 v[172:175], v3, s[8:11], s31 offen offset:128
    buffer_load_dwordx4 v[176:179], v3, s[8:11], s31 offen offset:192
    s_waitcnt vmcnt(0)
    v_mfma_f32_16x16x32_bf16 v[100:103], v[148:151], v[4:7], 0
    v_mfma_f32_16x16x32_bf16 v[100:103], v[152:155], v[8:11], v[100:103]
    v_mfma_f32_16x16x32_bf16 v[100:103], v[156:159], v[12:15], v[100:103]
    v_mfma_f32_16x16x32_bf16 v[100:103], v[160:163], v[16:19], v[100:103]
    v_mfma_f32_16x16x32_bf16 v[108:111], v[148:151], v[20:23], 0
    v_mfma_f32_16x16x32_bf16 v[108:111], v[152:155], v[24:27], v[108:111]
    v_mfma_f32_16x16x32_bf16 v[108:111], v[156:159], v[28:31], v[108:111]
    v_mfma_f32_16x16x32_bf16 v[108:111], v[160:163], v[32:35], v[108:111]
    v_mfma_f32_16x16x32_bf16 v[104:107], v[164:167], v[4:7], 0
    v_mfma_f32_16x16x32_bf16 v[104:107], v[168:171], v[8:11], v[104:107]
    v_mfma_f32_16x16x32_bf16 v[104:107], v[172:175], v[12:15], v[104:107]
    v_mfma_f32_16x16x32_bf16 v[104:107], v[176:179], v[16:19], v[104:107]
    v_mfma_f32_16x16x32_bf16 v[112:115], v[164:167], v[20:23], 0
    v_mfma_f32_16x16x32_bf16 v[112:115], v[168:171], v[24:27], v[112:115]
    v_mfma_f32_16x16x32_bf16 v[112:115], v[172:175], v[28:31], v[112:115]
    v_mfma_f32_16x16x32_bf16 v[112:115], v[176:179], v[32:35], v[112:115]
    s_nop 15
    v_max3_f32 v224, v224, v100, v101
    v_max3_f32 v224, v224, v102, v103
    v_max3_f32 v224, v224, v104, v105
    v_max3_f32 v224, v224, v106, v107
    v_max3_f32 v228, v228, v108, v109
    v_max3_f32 v228, v228, v110, v111
    v_max3_f32 v228, v228, v112, v113
    v_max3_f32 v228, v228, v114, v115
    s_add_u32 s31, s31, 8192
    s_cmp_lt_u32 s31, s43
    s_cbranch_scc1 L_redo_loop
    v_mov_b32 v1, v224
    v_mov_b32 v2, v228
    s_nop 1
    v_permlane32_swap_b32 v224, v1
    v_permlane32_swap_b32 v228, v2
    v_max_f32 v224, v224, v1
    v_max_f32 v228, v228, v2
    v_mov_b32 v1, v224
    v_mov_b32 v2, v228
    s_nop 1
    v_permlane16_swap_b32 v224, v1
    v_permlane16_swap_b32 v228, v2
    v_max_f32 v224, v224, v1
    v_max_f32 v228, v228, v2
    v_sub_f32 v224, 0, v224
    v_sub_f32 v228, 0, v228
    s_branch L_restart
.section .rodata,"a"
.p2align 6
.amdhsa_kernel standalone__gqa_softmax__near_ridge_kernel
  .amdhsa_next_free_vgpr 256
  .amdhsa_next_free_sgpr 102
  .amdhsa_accum_offset 256
  .amdhsa_group_segment_fixed_size 0
  .amdhsa_kernarg_size 48
  .amdhsa_user_sgpr_count 2
  .amdhsa_user_sgpr_kernarg_segment_ptr 1
  .amdhsa_system_sgpr_workgroup_id_x 1
.end_amdhsa_kernel
```
